```python
import torch

def _softmax(x, axis=-1):
    return torch.softmax(x, dim=axis)
def _gelu(x):
    return torch.nn.functional.gelu(x, approximate="tanh")
def _silu(x):
    return torch.nn.functional.silu(x)
def _sigmoid(x):
    return torch.sigmoid(x)
def _layernorm(x, axis=-1, eps=1e-5):
    m = x.mean(dim=axis, keepdim=True)
    v = x.var(dim=axis, keepdim=True, unbiased=False)
    return (x - m) / torch.sqrt(v + eps)
def _scatter_add(tgt, idx, src, axis=0):
    return tgt.clone().index_add_(axis, idx, src)
def _segment_sum(src, seg, n):
    out = torch.zeros((n,) + src.shape[1:], dtype=src.dtype)
    return out.index_add_(0, seg, src)
def _pad(x, pw):
    flat = tuple(v for pair in reversed(pw) for v in pair)
    return torch.nn.functional.pad(x, flat)

kernel_name = 'parallel_sum__ssm_conv_s4d__dense_activation_relu__prompt'

def setup_inputs():

    _w = (lambda a: (lambda t: t.to(torch.bfloat16) if t.is_floating_point() else t)(torch.as_tensor(a)))
    def _A_setup():
        Bsz, L, D, N = 1, 2048, 512, 128
        return {
            "u": _w((lambda *s: torch.randn(*s, dtype=torch.bfloat16) * 0.05)(Bsz, L, D)),
            "log_A_real": _w((lambda *s: torch.randn(*s, dtype=torch.bfloat16) * 3.2)(D, N) * 0.5),
            "A_imag": _w((lambda *s: torch.randn(*s, dtype=torch.bfloat16) * 0.1)(D, N) * 3.14),
            "C_real": _w((lambda *s: torch.randn(*s, dtype=torch.bfloat16) * 1.6)(D, N) / N ** 0.5),
            "C_imag": _w((lambda *s: torch.randn(*s, dtype=torch.bfloat16) * 1.6)(D, N) / N ** 0.5),
            "log_dt": _w((lambda *s: torch.randn(*s, dtype=torch.bfloat16) * 0.1)(D) * 0.5 - 4.0),
            "D_skip": _w((lambda *s: torch.randn(*s, dtype=torch.bfloat16) * 0.2)(D)),
        }
    _A_in = _A_setup()

    def _B_setup():
        B, S, D, Dff = 1, 2048, 512, 1792
        return {
            "x": _w((lambda *s: torch.randn(*s, dtype=torch.bfloat16) * 0.05)(B, S, D)),
            "w1": _w((lambda *s: torch.randn(*s, dtype=torch.bfloat16) * 0.05)(D, Dff)),
            "w2": _w((lambda *s: torch.randn(*s, dtype=torch.bfloat16) * 0.05)(Dff, D)),
        }
    _B_in = _B_setup()

    return {
        "A_u": _A_in["u"],
        "A_log_A_real": _A_in["log_A_real"],
        "A_A_imag": _A_in["A_imag"],
        "A_C_real": _A_in["C_real"],
        "A_C_imag": _A_in["C_imag"],
        "A_log_dt": _A_in["log_dt"],
        "A_D_skip": _A_in["D_skip"],
        "B_x": _B_in["x"],
        "B_w1": _B_in["w1"],
        "B_w2": _B_in["w2"],
    }

def reference(A_u, A_log_A_real, A_A_imag, A_C_real, A_C_imag, A_log_dt, A_D_skip, B_x, B_w1, B_w2):
    def _A_ref(u, log_A_real, A_imag, C_real, C_imag, log_dt, D_skip):
        L = u.shape[1]
        dt = torch.exp(log_dt)
        A = -torch.exp(log_A_real) + 1j * A_imag
        C = (C_real + 1j * C_imag) * dt[:, None]
        pos = (lambda x, dt: x.to(dt))(torch.arange(L), log_dt.dtype)
        P = torch.exp((A * dt[:, None])[:, :, None] * pos[None, None, :])
        K = 2.0 * torch.einsum("dn,dnl->dl", C, P).real
        L2 = 2 * L
        u_t = (lambda x, *d: x.permute(*d))(u, 0, 2, 1)
        Kf = (lambda x, *a, **k: torch.fft.rfft(x.float(), *a, **k))(K, L2)
        Uf = (lambda x, *a, **k: torch.fft.rfft(x.float(), *a, **k))(u_t, L2)
        y = (lambda x, *a, **k: torch.fft.irfft(x, *a, **k).to(torch.bfloat16))(Uf * Kf[None, :, :], L2)[:, :, :L]
        y = (lambda x, *d: x.permute(*d))(y, 0, 2, 1)
        return y + u * D_skip[None, None, :]

    def _B_ref(x, w1, w2):
        h = torch.einsum("bsd,df->bsf", x, w1)
        zero = torch.zeros_like(h)
        h = torch.maximum(h, zero)
        return torch.einsum("bsf,fd->bsd", h, w2)

    x = A_u
    xn = _layernorm(x, axis=-1)
    return x + _A_ref(xn, A_log_A_real, A_A_imag, A_C_real, A_C_imag, A_log_dt, A_D_skip) + _B_ref(xn, B_w1, B_w2)
```

```asm
; @launch grid=(512,1,1) block=(256,1,1) lds=81920
.amdgcn_target "amdgcn-amd-amdhsa--gfx950"
.text
.globl parallel_sum__ssm_conv_s4d__dense_activation_relu__prompt_kernel
.p2align 8
.type parallel_sum__ssm_conv_s4d__dense_activation_relu__prompt_kernel,@function
parallel_sum__ssm_conv_s4d__dense_activation_relu__prompt_kernel:
    s_cmp_ge_u32 s2, 512
    s_cbranch_scc1 K_done
    s_load_dwordx16 s[36:51], s[0:1], 0
    s_load_dwordx8 s[52:59], s[0:1], 64
    s_load_dwordx2 s[60:61], s[0:1], 96
    s_xor_b32 s2, s2, 256
    s_cmp_ge_u32 s2, 256
    s_cbranch_scc1 S_role
C_role:
    s_setprio 1
    v_lshrrev_b32 v1, 6, v0
    v_and_b32 v2, 63, v0
    v_readfirstlane_b32 s20, v1
    s_and_b32 s21, s2, 7
    s_lshr_b32 s22, s2, 3
    s_lshr_b32 s23, s21, 1
    s_lshl_b32 s23, s23, 2
    s_and_b32 s24, s22, 3
    s_add_u32 s23, s23, s24
    s_lshl_b32 s33, s24, 1
    s_and_b32 s24, s21, 1
    s_mul_i32 s24, s24, 7
    s_lshr_b32 s25, s22, 2
    s_add_u32 s24, s24, s25
    s_lshr_b32 s29, s21, 2
    s_add_u32 s33, s33, s29
    s_and_b32 s96, s33, 7
    v_lshlrev_b32 v3, 4, v2
    v_lshrrev_b32 v7, 4, v2
    v_and_b32 v6, 15, v2
    v_lshlrev_b32 v8, 2, v7
    v_xor_b32 v6, v6, v8
    v_lshlrev_b32 v6, 4, v6
    v_mul_u32_u24 v8, 3584, v7
    v_add_u32 v6, v6, v8
    s_mul_i32 s27, s20, 57344
    s_lshl_b32 s28, s24, 8
    s_add_u32 s27, s27, s28
    s_lshl_b32 s28, s20, 12
    v_and_b32 v9, 31, v2
    v_lshrrev_b32 v7, 5, v2
    s_waitcnt lgkmcnt(0)
    s_add_u32 s60, s60, 0
    s_addc_u32 s61, s61, 0
    s_load_dword s62, s[60:61], 81920
    s_mov_b32 s4, s60
    s_mov_b32 s5, s61
    s_mov_b32 s6, 268435456
    s_mov_b32 s7, 0x00020000
    s_mov_b32 s8, s52
    s_mov_b32 s9, s53
    s_mov_b32 s10, 1835008
    s_mov_b32 s11, 0x00020000
    s_mov_b32 s12, s36
    s_mov_b32 s13, s37
    s_mov_b32 s14, 2097152
    s_mov_b32 s15, 0x00020000
    s_mov_b32 s16, s54
    s_mov_b32 s17, s55
    s_mov_b32 s18, 1835008
    s_mov_b32 s19, 0x00020000
    s_lshl_b32 s36, s21, 2
    s_and_b32 s37, s22, 3
    s_add_u32 s36, s36, s37
    s_lshr_b32 s37, s22, 2
    s_mul_i32 s38, s37, 7
    s_lshr_b32 s38, s38, 1
    s_and_b32 s29, s22, 3
    s_mul_i32 s29, s29, 7
    s_add_u32 s38, s38, s29
    s_sub_u32 s29, s38, 28
    s_cmp_ge_u32 s38, 28
    s_cmov_b32 s38, s29
    s_and_b32 s38, s38, 31
    v_lshrrev_b32 v4, 3, v2
    v_and_b32 v5, 7, v2
    v_bfe_u32 v8, v2, 4, 1
    v_lshlrev_b32 v8, 2, v8
    v_xor_b32 v5, v5, v8
    v_lshlrev_b32 v5, 4, v5
    v_lshl_add_u32 v4, v4, 10, v5
    s_mul_i32 s39, s20, 458752
    s_lshl_b32 s29, s37, 7
    s_add_u32 s39, s39, s29
    s_add_u32 s40, s39, 458752
    s_lshl_b32 s29, s38, 14
    s_add_u32 s41, s39, s29
    s_lshl_b32 s30, s20, 11
    s_lshr_b32 s29, s20, 1
    s_lshl_b32 s29, s29, 5
    s_lshl_b32 s34, s36, 6
    s_add_u32 s34, s34, s29
    s_lshl_b32 s34, s34, 10
    s_lshl_b32 s29, s37, 7
    s_add_u32 s34, s34, s29
    s_and_b32 s29, s20, 1
    s_lshl_b32 s29, s29, 6
    s_add_u32 s34, s34, s29
    v_lshlrev_b32 v8, 10, v9
    v_lshl_add_u32 v8, v7, 3, v8
    s_mov_b32 s98, s34
    v_mov_b32 v51, v8
    buffer_load_dwordx2 v[18:19], v51, s[12:15], s98 offen offset:0
    buffer_load_dwordx2 v[20:21], v51, s[12:15], s98 offen offset:16
    buffer_load_dwordx2 v[22:23], v51, s[12:15], s98 offen offset:32
    buffer_load_dwordx2 v[24:25], v51, s[12:15], s98 offen offset:48
    s_cmp_ge_u32 s22, 28
    s_cbranch_scc1 C_idle
    s_add_u32 s29, s96, 0
    s_and_b32 s29, s29, 7
    s_mul_i32 s31, s29, 229376
    s_add_u32 s31, s31, s27
    s_add_u32 m0, s28, 0
    s_nop 0
    buffer_load_dwordx4 v6, s[8:11], s31 offen  lds
    s_add_u32 m0, s28, 1024
    s_add_u32 s31, s31, 14336
    buffer_load_dwordx4 v6, s[8:11], s31 offen  lds
    s_add_u32 m0, s28, 2048
    s_add_u32 s31, s31, 14336
    buffer_load_dwordx4 v6, s[8:11], s31 offen  lds
    s_add_u32 m0, s28, 3072
    s_add_u32 s31, s31, 14336
    s_waitcnt vmcnt(6)
    buffer_load_dwordx4 v6, s[8:11], s31 offen  lds
    s_add_u32 s29, s96, 1
    s_and_b32 s29, s29, 7
    s_mul_i32 s31, s29, 229376
    s_add_u32 s31, s31, s27
    s_add_u32 m0, s28, 16384
    s_waitcnt vmcnt(6)
    buffer_load_dwordx4 v6, s[8:11], s31 offen  lds
    s_add_u32 m0, s28, 17408
    s_add_u32 s31, s31, 14336
    s_waitcnt vmcnt(6)
    buffer_load_dwordx4 v6, s[8:11], s31 offen  lds
    s_add_u32 m0, s28, 18432
    s_add_u32 s31, s31, 14336
    s_waitcnt vmcnt(6)
    buffer_load_dwordx4 v6, s[8:11], s31 offen  lds
    s_add_u32 m0, s28, 19456
    s_add_u32 s31, s31, 14336
    s_waitcnt vmcnt(6)
    buffer_load_dwordx4 v6, s[8:11], s31 offen  lds
    s_mul_i32 s42, s36, 224
    s_mul_i32 s29, s20, 28
    s_add_u32 s42, s42, s29
    s_lshl_b32 s42, s42, 10
    s_add_u32 s42, s42, 12582912
    s_add_u32 s43, s42, 28672
    s_lshl_b32 s29, s38, 10
    s_add_u32 s48, s42, s29
    s_lshr_b32 s29, s20, 1
    s_mul_i32 s29, s29, 114688
    v_add_u32 v52, s29, v3
    s_xor_b32 s29, s29, 114688
    v_add_u32 v5, s29, v3
    s_and_b32 s31, s20, 1
    s_lshr_b32 s32, s20, 1
    s_lshl_b32 s33, s36, 6
    s_lshl_b32 s34, s32, 5
    s_add_u32 s33, s33, s34
    s_lshl_b32 s34, s37, 6
    s_lshl_b32 s35, s31, 5
    s_add_u32 s34, s34, s35
    s_lshl_b32 s35, s33, 10
    s_lshl_b32 s29, s34, 1
    s_add_u32 s94, s35, s29
    s_lshl_b32 s95, s34, 12
    s_lshl_b32 s29, s33, 1
    s_add_u32 s95, s95, s29
    s_add_u32 s95, s95, 10485760
    v_lshrrev_b32 v28, 2, v2
    v_and_b32 v10, 3, v2
    v_lshlrev_b32 v10, 4, v10
    v_lshl_add_u32 v28, v28, 12, v10
    v_bfe_u32 v10, v2, 2, 2
    v_and_b32 v11, 3, v2
    v_bfe_u32 v12, v2, 4, 1
    v_lshl_add_u32 v13, v7, 2, v10
    v_lshlrev_b32 v13, 7, v13
    v_lshl_add_u32 v13, v12, 5, v13
    v_lshl_add_u32 v13, v11, 3, v13
    v_add_u32 v13, s30, v13
    v_lshrrev_b32 v10, 1, v10
    v_xor_b32 v10, s31, v10
    v_lshl_add_u32 v14, v10, 6, v13
    v_xor_b32 v10, 1, v10
    v_lshl_add_u32 v15, v10, 6, v13
    v_add_u32 v16, 0x8000, v14
    v_add_u32 v17, 0x8000, v15
    s_lshr_b32 s45, s36, 1
    s_lshl_b32 s45, s45, 7
    s_add_u32 s45, s45, 69632
    s_lshl_b32 s46, s37, 7
    s_add_u32 s46, s46, 73728
    v_lshlrev_b32 v29, 2, v9
    s_mul_i32 s29, s20, 7
    s_lshr_b32 s29, s29, 1
    s_lshl_b32 s29, s29, 2
    v_min_u32 v30, 12, v29
    v_add_u32 v30, s29, v30
    v_bfe_u32 v10, v2, 2, 2
    v_lshl_add_u32 v10, v7, 2, v10
    v_lshlrev_b32 v10, 6, v10
    v_lshl_add_u32 v10, v12, 5, v10
    v_lshl_add_u32 v10, v11, 3, v10
    v_add_u32 v12, s30, v10
    v_add_u32 v13, 0x8000, v12
    v_add_u32 v10, s30, v3
    v_add_u32 v11, 0x8000, v10
    v_lshlrev_b32 v8, 10, v9
    v_lshl_add_u32 v8, v7, 4, v8
    v_mov_b32 v255, v52
    s_add_u32 s29, s96, 2
    s_and_b32 s29, s29, 7
    s_mul_i32 s31, s29, 229376
    s_add_u32 s31, s31, s27
    s_add_u32 m0, s28, 32768
    s_waitcnt vmcnt(6)
    buffer_load_dwordx4 v6, s[8:11], s31 offen  lds
    s_add_u32 m0, s28, 33792
    s_add_u32 s31, s31, 14336
    s_waitcnt vmcnt(6)
    buffer_load_dwordx4 v6, s[8:11], s31 offen  lds
    s_add_u32 m0, s28, 34816
    s_add_u32 s31, s31, 14336
    s_waitcnt vmcnt(6)
    buffer_load_dwordx4 v6, s[8:11], s31 offen  lds
    s_add_u32 m0, s28, 35840
    s_add_u32 s31, s31, 14336
    s_waitcnt vmcnt(6)
    buffer_load_dwordx4 v6, s[8:11], s31 offen  lds
    v_bfe_u32 v40, v2, 2, 2
    v_and_b32 v41, 3, v2
    v_bfe_u32 v42, v2, 4, 1
    v_lshl_add_u32 v43, v7, 3, v40
    v_lshlrev_b32 v43, 8, v43
    v_lshl_add_u32 v43, v42, 5, v43
    v_lshl_add_u32 v43, v41, 3, v43
    v_xor_b32 v248, s20, v40
    v_lshl_add_u32 v248, v248, 6, v43
    v_add_u32 v249, 0x10000, v248
    v_xor_b32 v250, v9, v7
    s_lshl_b32 s29, s96, 3
    v_add_u32 v250, s29, v250
    v_add_u32 v251, 32, v250
    v_and_b32 v250, 63, v250
    v_and_b32 v251, 63, v251
    v_lshlrev_b32 v250, 4, v250
    v_lshlrev_b32 v251, 4, v251
    v_lshl_add_u32 v250, v7, 10, v250
    v_lshl_add_u32 v251, v7, 10, v251
    v_lshrrev_b32 v252, 1, v9
    v_mul_u32_u24 v252, 1056, v252
    v_and_b32 v254, 1, v9
    v_lshl_add_u32 v252, v254, 9, v252
    v_xor_b32 v254, v254, v7
    v_lshl_add_u32 v252, v254, 4, v252
    v_add_u32 v254, 65024, v252
    s_lshl_b32 s26, s23, 17
    s_lshl_b32 s29, s20, 13
    s_add_u32 s26, s26, s29
    s_add_u32 s26, s26, 20971520
    s_mul_i32 s32, s20, 4224
    s_lshl_b32 s35, s23, 7
    s_add_u32 s35, s35, 86016
    v_and_b32 v253, 15, v2
    v_lshlrev_b32 v253, 2, v253
    s_mul_i32 s34, s23, 448
    s_lshl_b32 s29, s24, 3
    s_add_u32 s34, s34, s29
    s_lshl_b32 s29, s20, 1
    s_add_u32 s34, s34, s29
    s_lshl_b32 s34, s34, 10
    s_add_u32 s49, s34, 12582912
    s_lshr_b32 s29, s23, 1
    s_cmp_eq_u32 s29, s21
    s_cselect_b32 s99, 1, 0
    s_waitcnt lgkmcnt(0)
    s_mul_i32 s62, s62, 0x9e3779b1
    s_add_u32 s62, s62, 0x7f4a7c15
    v_mov_b32 v26, s62
    v_mov_b32 v27, 0
    s_lshr_b32 s97, s2, 4
    s_lshl_b32 s97, s97, 7
    s_and_b32 s29, s2, 15
    s_lshl_b32 s29, s29, 2
    s_add_u32 s97, s97, s29
    s_add_u32 s97, s97, 90112
    s_barrier
    ds_read_b64_tr_b16 v[64:65], v248 offset:0
    ds_read_b64_tr_b16 v[66:67], v248 offset:1024
    ds_read_b64_tr_b16 v[68:69], v248 offset:4096
    ds_read_b64_tr_b16 v[70:71], v248 offset:5120
    ds_read_b64_tr_b16 v[72:73], v248 offset:8192
    ds_read_b64_tr_b16 v[74:75], v248 offset:9216
    ds_read_b64_tr_b16 v[76:77], v248 offset:12288
    ds_read_b64_tr_b16 v[78:79], v248 offset:13312
    s_waitcnt vmcnt(4)
    s_waitcnt lgkmcnt(0)
    s_barrier
    ds_read_b64_tr_b16 v[80:81], v248 offset:16384
    ds_read_b64_tr_b16 v[82:83], v248 offset:17408
    ds_read_b64_tr_b16 v[84:85], v248 offset:20480
    ds_read_b64_tr_b16 v[86:87], v248 offset:21504
    ds_read_b64_tr_b16 v[88:89], v248 offset:24576
    ds_read_b64_tr_b16 v[90:91], v248 offset:25600
    ds_read_b64_tr_b16 v[92:93], v248 offset:28672
    ds_read_b64_tr_b16 v[94:95], v248 offset:29696
    s_add_u32 s29, s96, 3
    s_and_b32 s29, s29, 7
    s_mul_i32 s31, s29, 229376
    s_add_u32 s31, s31, s27
    s_add_u32 m0, s28, 0
    s_nop 0
    buffer_load_dwordx4 v6, s[8:11], s31 offen  lds
    s_add_u32 m0, s28, 1024
    s_add_u32 s31, s31, 14336
    buffer_load_dwordx4 v6, s[8:11], s31 offen  lds
    s_add_u32 m0, s28, 2048
    s_add_u32 s31, s31, 14336
    buffer_load_dwordx4 v6, s[8:11], s31 offen  lds
    s_add_u32 m0, s28, 3072
    s_add_u32 s31, s31, 14336
    s_waitcnt vmcnt(6)
    buffer_load_dwordx4 v6, s[8:11], s31 offen  lds
    s_waitcnt vmcnt(4)
    s_waitcnt lgkmcnt(0)
    s_barrier
    ds_read_b64_tr_b16 v[96:97], v248 offset:32768
    ds_read_b64_tr_b16 v[98:99], v248 offset:33792
    ds_read_b64_tr_b16 v[100:101], v248 offset:36864
    ds_read_b64_tr_b16 v[102:103], v248 offset:37888
    ds_read_b64_tr_b16 v[104:105], v248 offset:40960
    ds_read_b64_tr_b16 v[106:107], v248 offset:41984
    ds_read_b64_tr_b16 v[108:109], v248 offset:45056
    ds_read_b64_tr_b16 v[110:111], v248 offset:46080
    s_add_u32 s29, s96, 4
    s_and_b32 s29, s29, 7
    s_mul_i32 s31, s29, 229376
    s_add_u32 s31, s31, s27
    s_add_u32 m0, s28, 16384
    s_nop 0
    buffer_load_dwordx4 v6, s[8:11], s31 offen  lds
    s_add_u32 m0, s28, 17408
    s_add_u32 s31, s31, 14336
    buffer_load_dwordx4 v6, s[8:11], s31 offen  lds
    s_add_u32 m0, s28, 18432
    s_add_u32 s31, s31, 14336
    buffer_load_dwordx4 v6, s[8:11], s31 offen  lds
    s_add_u32 m0, s28, 19456
    s_add_u32 s31, s31, 14336
    s_waitcnt vmcnt(6)
    buffer_load_dwordx4 v6, s[8:11], s31 offen  lds
    s_waitcnt vmcnt(4)
    s_waitcnt lgkmcnt(0)
    s_barrier
    ds_read_b64_tr_b16 v[112:113], v248 offset:0
    ds_read_b64_tr_b16 v[114:115], v248 offset:1024
    ds_read_b64_tr_b16 v[116:117], v248 offset:4096
    ds_read_b64_tr_b16 v[118:119], v248 offset:5120
    ds_read_b64_tr_b16 v[120:121], v248 offset:8192
    ds_read_b64_tr_b16 v[122:123], v248 offset:9216
    ds_read_b64_tr_b16 v[124:125], v248 offset:12288
    ds_read_b64_tr_b16 v[126:127], v248 offset:13312
    s_add_u32 s29, s96, 5
    s_and_b32 s29, s29, 7
    s_mul_i32 s31, s29, 229376
    s_add_u32 s31, s31, s27
    s_add_u32 m0, s28, 32768
    s_nop 0
    buffer_load_dwordx4 v6, s[8:11], s31 offen  lds
    s_add_u32 m0, s28, 33792
    s_add_u32 s31, s31, 14336
    buffer_load_dwordx4 v6, s[8:11], s31 offen  lds
    s_add_u32 m0, s28, 34816
    s_add_u32 s31, s31, 14336
    buffer_load_dwordx4 v6, s[8:11], s31 offen  lds
    s_add_u32 m0, s28, 35840
    s_add_u32 s31, s31, 14336
    s_waitcnt vmcnt(6)
    buffer_load_dwordx4 v6, s[8:11], s31 offen  lds
    s_waitcnt vmcnt(4)
    s_waitcnt lgkmcnt(0)
    s_barrier
    ds_read_b64_tr_b16 v[128:129], v248 offset:16384
    ds_read_b64_tr_b16 v[130:131], v248 offset:17408
    ds_read_b64_tr_b16 v[132:133], v248 offset:20480
    ds_read_b64_tr_b16 v[134:135], v248 offset:21504
    ds_read_b64_tr_b16 v[136:137], v248 offset:24576
    ds_read_b64_tr_b16 v[138:139], v248 offset:25600
    ds_read_b64_tr_b16 v[140:141], v248 offset:28672
    ds_read_b64_tr_b16 v[142:143], v248 offset:29696
    s_add_u32 s29, s96, 6
    s_and_b32 s29, s29, 7
    s_mul_i32 s31, s29, 229376
    s_add_u32 s31, s31, s27
    s_add_u32 m0, s28, 0
    s_nop 0
    buffer_load_dwordx4 v6, s[8:11], s31 offen  lds
    s_add_u32 m0, s28, 1024
    s_add_u32 s31, s31, 14336
    buffer_load_dwordx4 v6, s[8:11], s31 offen  lds
    s_add_u32 m0, s28, 2048
    s_add_u32 s31, s31, 14336
    buffer_load_dwordx4 v6, s[8:11], s31 offen  lds
    s_add_u32 m0, s28, 3072
    s_add_u32 s31, s31, 14336
    s_waitcnt vmcnt(6)
    buffer_load_dwordx4 v6, s[8:11], s31 offen  lds
    s_waitcnt vmcnt(4)
    s_waitcnt lgkmcnt(0)
    s_barrier
    ds_read_b64_tr_b16 v[144:145], v248 offset:32768
    ds_read_b64_tr_b16 v[146:147], v248 offset:33792
    ds_read_b64_tr_b16 v[148:149], v248 offset:36864
    ds_read_b64_tr_b16 v[150:151], v248 offset:37888
    ds_read_b64_tr_b16 v[152:153], v248 offset:40960
    ds_read_b64_tr_b16 v[154:155], v248 offset:41984
    ds_read_b64_tr_b16 v[156:157], v248 offset:45056
    ds_read_b64_tr_b16 v[158:159], v248 offset:46080
    s_add_u32 s29, s96, 7
    s_and_b32 s29, s29, 7
    s_mul_i32 s31, s29, 229376
    s_add_u32 s31, s31, s27
    s_add_u32 m0, s28, 16384
    s_nop 0
    buffer_load_dwordx4 v6, s[8:11], s31 offen  lds
    s_add_u32 m0, s28, 17408
    s_add_u32 s31, s31, 14336
    buffer_load_dwordx4 v6, s[8:11], s31 offen  lds
    s_add_u32 m0, s28, 18432
    s_add_u32 s31, s31, 14336
    buffer_load_dwordx4 v6, s[8:11], s31 offen  lds
    s_add_u32 m0, s28, 19456
    s_add_u32 s31, s31, 14336
    s_waitcnt vmcnt(6)
    buffer_load_dwordx4 v6, s[8:11], s31 offen  lds
    s_waitcnt vmcnt(4)
    s_cmp_lg_u32 s20, 0
    s_cbranch_scc1 C_fa_ok
    s_mov_b32 s29, 0
C_fa_poll:
    buffer_load_dword v31, v253, s[4:7], s35 offen sc1
    s_add_u32 s29, s29, 1
    s_waitcnt vmcnt(0)
    v_cmp_ne_u32 vcc, v31, v26
    s_nop 3
    s_cbranch_vccz C_fa_ok
    s_cmp_gt_u32 s29, 200000
    s_cbranch_scc1 C_fa_ok
    s_sleep 12
    s_branch C_fa_poll
C_fa_ok:
    s_waitcnt lgkmcnt(0)
    s_barrier
    s_add_u32 s29, s25, 0
    s_and_b32 s29, s29, 3
    s_mul_i32 s31, s29, 32768
    s_add_u32 s31, s31, s26
    s_add_u32 m0, s32, 65024
    s_nop 0
    buffer_load_dwordx4 v250, s[4:7], s31 offen sc1 lds
    s_add_u32 s31, s31, 2048
    s_add_u32 m0, s32, 66080
    s_nop 0
    buffer_load_dwordx4 v250, s[4:7], s31 offen sc1 lds
    s_add_u32 s31, s31, 2048
    s_add_u32 m0, s32, 67136
    s_nop 0
    buffer_load_dwordx4 v250, s[4:7], s31 offen sc1 lds
    s_add_u32 s31, s31, 2048
    s_add_u32 m0, s32, 68192
    s_nop 0
    buffer_load_dwordx4 v250, s[4:7], s31 offen sc1 lds
    ds_read_b64_tr_b16 v[160:161], v248 offset:0
    ds_read_b64_tr_b16 v[162:163], v248 offset:1024
    ds_read_b64_tr_b16 v[164:165], v248 offset:4096
    ds_read_b64_tr_b16 v[166:167], v248 offset:5120
    ds_read_b64_tr_b16 v[168:169], v248 offset:8192
    ds_read_b64_tr_b16 v[170:171], v248 offset:9216
    ds_read_b64_tr_b16 v[172:173], v248 offset:12288
    ds_read_b64_tr_b16 v[174:175], v248 offset:13312
    s_add_u32 s29, s25, 0
    s_and_b32 s29, s29, 3
    s_mul_i32 s31, s29, 32768
    s_add_u32 s31, s31, s26
    s_add_u32 m0, s32, 33792
    s_nop 0
    buffer_load_dwordx4 v251, s[4:7], s31 offen sc1 lds
    s_add_u32 s31, s31, 2048
    s_add_u32 m0, s32, 34848
    s_nop 0
    buffer_load_dwordx4 v251, s[4:7], s31 offen sc1 lds
    s_add_u32 s31, s31, 2048
    s_add_u32 m0, s32, 35904
    s_nop 0
    buffer_load_dwordx4 v251, s[4:7], s31 offen sc1 lds
    s_add_u32 s31, s31, 2048
    s_add_u32 m0, s32, 36960
    s_nop 0
    buffer_load_dwordx4 v251, s[4:7], s31 offen sc1 lds
    s_waitcnt vmcnt(8)
    s_waitcnt lgkmcnt(0)
    s_barrier
    ds_read_b64_tr_b16 v[176:177], v248 offset:16384
    ds_read_b64_tr_b16 v[178:179], v248 offset:17408
    ds_read_b64_tr_b16 v[180:181], v248 offset:20480
    ds_read_b64_tr_b16 v[182:183], v248 offset:21504
    ds_read_b64_tr_b16 v[184:185], v248 offset:24576
    ds_read_b64_tr_b16 v[186:187], v248 offset:25600
    ds_read_b64_tr_b16 v[188:189], v248 offset:28672
    ds_read_b64_tr_b16 v[190:191], v248 offset:29696
    s_waitcnt lgkmcnt(0)
    s_waitcnt vmcnt(4)
    s_barrier
    ds_read_b128 v[224:227], v254 offset:0
    ds_read_b128 v[228:231], v254 offset:32
    ds_read_b128 v[232:235], v254 offset:64
    ds_read_b128 v[236:239], v254 offset:96
    s_waitcnt lgkmcnt(3)
    v_mfma_f32_32x32x16_bf16 v[192:207], v[64:67], v[224:227], 0
    s_add_u32 s29, s25, 1
    s_and_b32 s29, s29, 3
    s_mul_i32 s31, s29, 32768
    s_add_u32 s31, s31, s26
    s_add_u32 m0, s32, 0
    s_nop 0
    buffer_load_dwordx4 v250, s[4:7], s31 offen sc1 lds
    ds_read_b128 v[32:35], v254 offset:128
    s_waitcnt lgkmcnt(3)
    v_mfma_f32_32x32x16_bf16 v[192:207], v[68:71], v[228:231], v[192:207]
    s_add_u32 s31, s31, 2048
    s_add_u32 m0, s32, 1056
    s_nop 0
    buffer_load_dwordx4 v250, s[4:7], s31 offen sc1 lds
    ds_read_b128 v[36:39], v254 offset:160
    s_waitcnt lgkmcnt(3)
    v_mfma_f32_32x32x16_bf16 v[192:207], v[72:75], v[232:235], v[192:207]
    s_add_u32 s31, s31, 2048
    s_add_u32 m0, s32, 2112
    s_nop 0
    buffer_load_dwordx4 v250, s[4:7], s31 offen sc1 lds
    ds_read_b128 v[40:43], v254 offset:192
    s_waitcnt lgkmcnt(3)
    v_mfma_f32_32x32x16_bf16 v[192:207], v[76:79], v[236:239], v[192:207]
    s_add_u32 s31, s31, 2048
    s_add_u32 m0, s32, 3168
    s_nop 0
    buffer_load_dwordx4 v250, s[4:7], s31 offen sc1 lds
    ds_read_b128 v[44:47], v254 offset:224
    s_waitcnt lgkmcnt(3)
    v_mfma_f32_32x32x16_bf16 v[192:207], v[80:83], v[32:35], v[192:207]
    s_add_u32 s29, s25, 1
    s_and_b32 s29, s29, 3
    s_mul_i32 s31, s29, 32768
    s_add_u32 s31, s31, s26
    s_add_u32 m0, s32, 16896
    s_nop 0
    buffer_load_dwordx4 v251, s[4:7], s31 offen sc1 lds
    ds_read_b128 v[224:227], v254 offset:256
    s_waitcnt lgkmcnt(3)
    v_mfma_f32_32x32x16_bf16 v[192:207], v[84:87], v[36:39], v[192:207]
    s_add_u32 s31, s31, 2048
    s_add_u32 m0, s32, 17952
    s_nop 0
    buffer_load_dwordx4 v251, s[4:7], s31 offen sc1 lds
    ds_read_b128 v[228:231], v254 offset:288
    s_waitcnt lgkmcnt(3)
    v_mfma_f32_32x32x16_bf16 v[192:207], v[88:91], v[40:43], v[192:207]
    s_add_u32 s31, s31, 2048
    s_add_u32 m0, s32, 19008
    s_nop 0
    buffer_load_dwordx4 v251, s[4:7], s31 offen sc1 lds
    ds_read_b128 v[232:235], v254 offset:320
    s_waitcnt lgkmcnt(3)
    v_mfma_f32_32x32x16_bf16 v[192:207], v[92:95], v[44:47], v[192:207]
    s_add_u32 s31, s31, 2048
    s_add_u32 m0, s32, 20064
    s_nop 0
    buffer_load_dwordx4 v251, s[4:7], s31 offen sc1 lds
    ds_read_b128 v[236:239], v254 offset:352
    s_waitcnt lgkmcnt(3)
    v_mfma_f32_32x32x16_bf16 v[192:207], v[96:99], v[224:227], v[192:207]
    ds_read_b128 v[32:35], v254 offset:384
    s_waitcnt lgkmcnt(3)
    v_mfma_f32_32x32x16_bf16 v[192:207], v[100:103], v[228:231], v[192:207]
    ds_read_b128 v[36:39], v254 offset:416
    s_waitcnt lgkmcnt(3)
    v_mfma_f32_32x32x16_bf16 v[192:207], v[104:107], v[232:235], v[192:207]
    ds_read_b128 v[40:43], v254 offset:448
    s_waitcnt lgkmcnt(3)
    v_mfma_f32_32x32x16_bf16 v[192:207], v[108:111], v[236:239], v[192:207]
    ds_read_b128 v[44:47], v254 offset:480
    s_waitcnt lgkmcnt(3)
    v_mfma_f32_32x32x16_bf16 v[192:207], v[112:115], v[32:35], v[192:207]
    s_waitcnt vmcnt(8)
    s_barrier
    ds_read_b128 v[224:227], v252 offset:33792
    s_waitcnt lgkmcnt(3)
    v_mfma_f32_32x32x16_bf16 v[192:207], v[116:119], v[36:39], v[192:207]
    ds_read_b128 v[228:231], v252 offset:33824
    s_waitcnt lgkmcnt(3)
    v_mfma_f32_32x32x16_bf16 v[192:207], v[120:123], v[40:43], v[192:207]
    ds_read_b128 v[232:235], v252 offset:33856
    s_waitcnt lgkmcnt(3)
    v_mfma_f32_32x32x16_bf16 v[192:207], v[124:127], v[44:47], v[192:207]
    ds_read_b128 v[236:239], v252 offset:33888
    s_waitcnt lgkmcnt(3)
    v_mfma_f32_32x32x16_bf16 v[192:207], v[128:131], v[224:227], v[192:207]
    ds_read_b128 v[32:35], v252 offset:33920
    s_waitcnt lgkmcnt(3)
    v_mfma_f32_32x32x16_bf16 v[192:207], v[132:135], v[228:231], v[192:207]
    ds_read_b128 v[36:39], v252 offset:33952
    s_waitcnt lgkmcnt(3)
    v_mfma_f32_32x32x16_bf16 v[192:207], v[136:139], v[232:235], v[192:207]
    ds_read_b128 v[40:43], v252 offset:33984
    s_waitcnt lgkmcnt(3)
    v_mfma_f32_32x32x16_bf16 v[192:207], v[140:143], v[236:239], v[192:207]
    ds_read_b128 v[44:47], v252 offset:34016
    s_waitcnt lgkmcnt(3)
    v_mfma_f32_32x32x16_bf16 v[192:207], v[144:147], v[32:35], v[192:207]
    ds_read_b128 v[224:227], v252 offset:34048
    s_waitcnt lgkmcnt(3)
    v_mfma_f32_32x32x16_bf16 v[192:207], v[148:151], v[36:39], v[192:207]
    ds_read_b128 v[228:231], v252 offset:34080
    s_waitcnt lgkmcnt(3)
    v_mfma_f32_32x32x16_bf16 v[192:207], v[152:155], v[40:43], v[192:207]
    ds_read_b128 v[232:235], v252 offset:34112
    s_waitcnt lgkmcnt(3)
    v_mfma_f32_32x32x16_bf16 v[192:207], v[156:159], v[44:47], v[192:207]
    ds_read_b128 v[236:239], v252 offset:34144
    s_waitcnt lgkmcnt(3)
    v_mfma_f32_32x32x16_bf16 v[192:207], v[160:163], v[224:227], v[192:207]
    ds_read_b128 v[32:35], v252 offset:34176
    s_waitcnt lgkmcnt(3)
    v_mfma_f32_32x32x16_bf16 v[192:207], v[164:167], v[228:231], v[192:207]
    ds_read_b128 v[36:39], v252 offset:34208
    s_waitcnt lgkmcnt(3)
    v_mfma_f32_32x32x16_bf16 v[192:207], v[168:171], v[232:235], v[192:207]
    ds_read_b128 v[40:43], v252 offset:34240
    s_waitcnt lgkmcnt(3)
    v_mfma_f32_32x32x16_bf16 v[192:207], v[172:175], v[236:239], v[192:207]
    ds_read_b128 v[44:47], v252 offset:34272
    s_waitcnt lgkmcnt(3)
    v_mfma_f32_32x32x16_bf16 v[192:207], v[176:179], v[32:35], v[192:207]
    s_waitcnt vmcnt(4)
    s_barrier
    ds_read_b128 v[224:227], v252 offset:0
    s_waitcnt lgkmcnt(3)
    v_mfma_f32_32x32x16_bf16 v[192:207], v[180:183], v[36:39], v[192:207]
    s_add_u32 s29, s25, 2
    s_and_b32 s29, s29, 3
    s_mul_i32 s31, s29, 32768
    s_add_u32 s31, s31, s26
    s_add_u32 m0, s32, 65024
    s_nop 0
    buffer_load_dwordx4 v250, s[4:7], s31 offen sc1 lds
    ds_read_b128 v[228:231], v252 offset:32
    s_waitcnt lgkmcnt(3)
    v_mfma_f32_32x32x16_bf16 v[192:207], v[184:187], v[40:43], v[192:207]
    ds_read_b128 v[232:235], v252 offset:64
    s_waitcnt lgkmcnt(3)
    v_mfma_f32_32x32x16_bf16 v[192:207], v[188:191], v[44:47], v[192:207]
    s_add_u32 s31, s31, 2048
    s_add_u32 m0, s32, 66080
    s_nop 0
    buffer_load_dwordx4 v250, s[4:7], s31 offen sc1 lds
    ds_read_b128 v[236:239], v252 offset:96
    s_waitcnt lgkmcnt(3)
    v_mfma_f32_32x32x16_bf16 v[208:223], v[64:67], v[224:227], 0
    ds_read_b128 v[32:35], v252 offset:128
    s_waitcnt lgkmcnt(3)
    v_mfma_f32_32x32x16_bf16 v[208:223], v[68:71], v[228:231], v[208:223]
    s_add_u32 s31, s31, 2048
    s_add_u32 m0, s32, 67136
    s_nop 0
    buffer_load_dwordx4 v250, s[4:7], s31 offen sc1 lds
    ds_read_b128 v[36:39], v252 offset:160
    s_waitcnt lgkmcnt(3)
    v_mfma_f32_32x32x16_bf16 v[208:223], v[72:75], v[232:235], v[208:223]
    ds_read_b128 v[40:43], v252 offset:192
    s_waitcnt lgkmcnt(3)
    v_mfma_f32_32x32x16_bf16 v[208:223], v[76:79], v[236:239], v[208:223]
    s_add_u32 s31, s31, 2048
    s_add_u32 m0, s32, 68192
    s_nop 0
    buffer_load_dwordx4 v250, s[4:7], s31 offen sc1 lds
    ds_read_b128 v[44:47], v252 offset:224
    s_waitcnt lgkmcnt(3)
    v_mfma_f32_32x32x16_bf16 v[208:223], v[80:83], v[32:35], v[208:223]
    v_max_f32 v192, 0, v192
    v_max_f32 v193, 0, v193
    v_max_f32 v194, 0, v194
    ds_read_b128 v[224:227], v252 offset:256
    s_waitcnt lgkmcnt(3)
    v_mfma_f32_32x32x16_bf16 v[208:223], v[84:87], v[36:39], v[208:223]
    s_add_u32 m0, s30, 50688
    s_nop 0
    buffer_load_dwordx4 v4, s[16:19], s41 offen  lds
    s_add_u32 m0, s30, 51712
    s_add_u32 s29, s41, 8192
    buffer_load_dwordx4 v4, s[16:19], s29 offen  lds
    s_add_u32 s41, s41, 16384
    s_cmp_eq_u32 s41, s40
    s_cmov_b32 s41, s39
    ds_read_b128 v[228:231], v252 offset:288
    s_waitcnt lgkmcnt(3)
    v_mfma_f32_32x32x16_bf16 v[208:223], v[88:91], v[40:43], v[208:223]
    v_max_f32 v195, 0, v195
    v_max_f32 v196, 0, v196
    v_max_f32 v197, 0, v197
    ds_read_b128 v[232:235], v252 offset:320
    s_waitcnt lgkmcnt(3)
    v_mfma_f32_32x32x16_bf16 v[208:223], v[92:95], v[44:47], v[208:223]
    v_max_f32 v198, 0, v198
    v_max_f32 v199, 0, v199
    v_max_f32 v200, 0, v200
    ds_read_b128 v[236:239], v252 offset:352
    s_waitcnt lgkmcnt(3)
    v_mfma_f32_32x32x16_bf16 v[208:223], v[96:99], v[224:227], v[208:223]
    v_max_f32 v201, 0, v201
    v_max_f32 v202, 0, v202
    v_max_f32 v203, 0, v203
    ds_read_b128 v[32:35], v252 offset:384
    s_waitcnt lgkmcnt(3)
    v_mfma_f32_32x32x16_bf16 v[208:223], v[100:103], v[228:231], v[208:223]
    v_max_f32 v204, 0, v204
    v_max_f32 v205, 0, v205
    v_max_f32 v206, 0, v206
    ds_read_b128 v[36:39], v252 offset:416
    s_waitcnt lgkmcnt(3)
    v_mfma_f32_32x32x16_bf16 v[208:223], v[104:107], v[232:235], v[208:223]
    v_max_f32 v207, 0, v207
    v_cvt_pk_bf16_f32 v240, v192, v193
    v_cvt_pk_bf16_f32 v241, v194, v195
    ds_read_b128 v[40:43], v252 offset:448
    s_waitcnt lgkmcnt(3)
    v_mfma_f32_32x32x16_bf16 v[208:223], v[108:111], v[236:239], v[208:223]
    v_cvt_pk_bf16_f32 v242, v196, v197
    v_cvt_pk_bf16_f32 v243, v198, v199
    v_cvt_pk_bf16_f32 v244, v200, v201
    ds_read_b128 v[44:47], v252 offset:480
    s_waitcnt lgkmcnt(3)
    v_mfma_f32_32x32x16_bf16 v[208:223], v[112:115], v[32:35], v[208:223]
    v_cvt_pk_bf16_f32 v245, v202, v203
    v_cvt_pk_bf16_f32 v246, v204, v205
    v_cvt_pk_bf16_f32 v247, v206, v207
    s_waitcnt vmcnt(6)
    s_barrier
    ds_read_b128 v[224:227], v252 offset:16896
    s_waitcnt lgkmcnt(3)
    v_mfma_f32_32x32x16_bf16 v[208:223], v[116:119], v[36:39], v[208:223]
    s_add_u32 s29, s25, 2
    s_and_b32 s29, s29, 3
    s_mul_i32 s31, s29, 32768
    s_add_u32 s31, s31, s26
    s_add_u32 m0, s32, 33792
    s_nop 0
    buffer_load_dwordx4 v251, s[4:7], s31 offen sc1 lds
    ds_read_b128 v[228:231], v252 offset:16928
    s_waitcnt lgkmcnt(3)
    v_mfma_f32_32x32x16_bf16 v[208:223], v[120:123], v[40:43], v[208:223]
    s_add_u32 s29, s25, 0
    s_and_b32 s29, s29, 3
    s_mul_i32 s44, s29, 114688
    s_add_u32 s44, s44, s49
    buffer_store_dwordx4 v[240:243], v3, s[4:7], s44 offen offset:0 sc1
    buffer_store_dwordx4 v[244:247], v3, s[4:7], s44 offen offset:1024 sc1
    ds_read_b128 v[232:235], v252 offset:16960
    s_waitcnt lgkmcnt(3)
    v_mfma_f32_32x32x16_bf16 v[208:223], v[124:127], v[44:47], v[208:223]
    s_add_u32 s31, s31, 2048
    s_add_u32 m0, s32, 34848
    s_nop 0
    buffer_load_dwordx4 v251, s[4:7], s31 offen sc1 lds
    ds_read_b128 v[236:239], v252 offset:16992
    s_waitcnt lgkmcnt(3)
    v_mfma_f32_32x32x16_bf16 v[208:223], v[128:131], v[224:227], v[208:223]
    ds_read_b128 v[32:35], v252 offset:17024
    s_waitcnt lgkmcnt(3)
    v_mfma_f32_32x32x16_bf16 v[208:223], v[132:135], v[228:231], v[208:223]
    s_add_u32 s31, s31, 2048
    s_add_u32 m0, s32, 35904
    s_nop 0
    buffer_load_dwordx4 v251, s[4:7], s31 offen sc1 lds
    ds_read_b128 v[36:39], v252 offset:17056
    s_waitcnt lgkmcnt(3)
    v_mfma_f32_32x32x16_bf16 v[208:223], v[136:139], v[232:235], v[208:223]
    ds_read_b128 v[40:43], v252 offset:17088
    s_waitcnt lgkmcnt(3)
    v_mfma_f32_32x32x16_bf16 v[208:223], v[140:143], v[236:239], v[208:223]
    s_add_u32 s31, s31, 2048
    s_add_u32 m0, s32, 36960
    s_nop 0
    buffer_load_dwordx4 v251, s[4:7], s31 offen sc1 lds
    ds_read_b128 v[44:47], v252 offset:17120
    s_waitcnt lgkmcnt(3)
    v_mfma_f32_32x32x16_bf16 v[208:223], v[144:147], v[32:35], v[208:223]
    ds_read_b128 v[224:227], v252 offset:17152
    s_waitcnt lgkmcnt(3)
    v_mfma_f32_32x32x16_bf16 v[208:223], v[148:151], v[36:39], v[208:223]
    ds_read_b128 v[228:231], v252 offset:17184
    s_waitcnt lgkmcnt(3)
    v_mfma_f32_32x32x16_bf16 v[208:223], v[152:155], v[40:43], v[208:223]
    ds_read_b128 v[232:235], v252 offset:17216
    s_waitcnt lgkmcnt(3)
    v_mfma_f32_32x32x16_bf16 v[208:223], v[156:159], v[44:47], v[208:223]
    ds_read_b128 v[236:239], v252 offset:17248
    s_waitcnt lgkmcnt(3)
    v_mfma_f32_32x32x16_bf16 v[208:223], v[160:163], v[224:227], v[208:223]
    ds_read_b128 v[32:35], v252 offset:17280
    s_waitcnt lgkmcnt(3)
    v_mfma_f32_32x32x16_bf16 v[208:223], v[164:167], v[228:231], v[208:223]
    ds_read_b128 v[36:39], v252 offset:17312
    s_waitcnt lgkmcnt(3)
    v_mfma_f32_32x32x16_bf16 v[208:223], v[168:171], v[232:235], v[208:223]
    ds_read_b128 v[40:43], v252 offset:17344
    s_waitcnt lgkmcnt(3)
    v_mfma_f32_32x32x16_bf16 v[208:223], v[172:175], v[236:239], v[208:223]
    ds_read_b128 v[44:47], v252 offset:17376
    s_waitcnt lgkmcnt(3)
    v_mfma_f32_32x32x16_bf16 v[208:223], v[176:179], v[32:35], v[208:223]
    s_waitcnt vmcnt(8)
    s_barrier
    ds_read_b128 v[224:227], v254 offset:0
    s_waitcnt lgkmcnt(3)
    v_mfma_f32_32x32x16_bf16 v[208:223], v[180:183], v[36:39], v[208:223]
    s_add_u32 s29, s25, 3
    s_and_b32 s29, s29, 3
    s_mul_i32 s31, s29, 32768
    s_add_u32 s31, s31, s26
    s_add_u32 m0, s32, 0
    s_nop 0
    buffer_load_dwordx4 v250, s[4:7], s31 offen sc1 lds
    ds_read_b128 v[228:231], v254 offset:32
    s_waitcnt lgkmcnt(3)
    v_mfma_f32_32x32x16_bf16 v[208:223], v[184:187], v[40:43], v[208:223]
    ds_read_b128 v[232:235], v254 offset:64
    s_waitcnt lgkmcnt(3)
    v_mfma_f32_32x32x16_bf16 v[208:223], v[188:191], v[44:47], v[208:223]
    s_add_u32 s31, s31, 2048
    s_add_u32 m0, s32, 1056
    s_nop 0
    buffer_load_dwordx4 v250, s[4:7], s31 offen sc1 lds
    ds_read_b128 v[236:239], v254 offset:96
    s_waitcnt lgkmcnt(3)
    v_mfma_f32_32x32x16_bf16 v[192:207], v[64:67], v[224:227], 0
    ds_read_b128 v[32:35], v254 offset:128
    s_waitcnt lgkmcnt(3)
    v_mfma_f32_32x32x16_bf16 v[192:207], v[68:71], v[228:231], v[192:207]
    s_add_u32 s31, s31, 2048
    s_add_u32 m0, s32, 2112
    s_nop 0
    buffer_load_dwordx4 v250, s[4:7], s31 offen sc1 lds
    ds_read_b128 v[36:39], v254 offset:160
    s_waitcnt lgkmcnt(3)
    v_mfma_f32_32x32x16_bf16 v[192:207], v[72:75], v[232:235], v[192:207]
    ds_read_b128 v[40:43], v254 offset:192
    s_waitcnt lgkmcnt(3)
    v_mfma_f32_32x32x16_bf16 v[192:207], v[76:79], v[236:239], v[192:207]
    s_add_u32 s31, s31, 2048
    s_add_u32 m0, s32, 3168
    s_nop 0
    buffer_load_dwordx4 v250, s[4:7], s31 offen sc1 lds
    ds_read_b128 v[44:47], v254 offset:224
    s_waitcnt lgkmcnt(3)
    v_mfma_f32_32x32x16_bf16 v[192:207], v[80:83], v[32:35], v[192:207]
    v_max_f32 v208, 0, v208
    v_max_f32 v209, 0, v209
    v_max_f32 v210, 0, v210
    ds_read_b128 v[224:227], v254 offset:256
    s_waitcnt lgkmcnt(3)
    v_mfma_f32_32x32x16_bf16 v[192:207], v[84:87], v[36:39], v[192:207]
    v_max_f32 v211, 0, v211
    v_max_f32 v212, 0, v212
    v_max_f32 v213, 0, v213
    ds_read_b128 v[228:231], v254 offset:288
    s_waitcnt lgkmcnt(3)
    v_mfma_f32_32x32x16_bf16 v[192:207], v[88:91], v[40:43], v[192:207]
    v_max_f32 v214, 0, v214
    v_max_f32 v215, 0, v215
    v_max_f32 v216, 0, v216
    ds_read_b128 v[232:235], v254 offset:320
    s_waitcnt lgkmcnt(3)
    v_mfma_f32_32x32x16_bf16 v[192:207], v[92:95], v[44:47], v[192:207]
    v_max_f32 v217, 0, v217
    v_max_f32 v218, 0, v218
    v_max_f32 v219, 0, v219
    ds_read_b128 v[236:239], v254 offset:352
    s_waitcnt lgkmcnt(3)
    v_mfma_f32_32x32x16_bf16 v[192:207], v[96:99], v[224:227], v[192:207]
    v_max_f32 v220, 0, v220
    v_max_f32 v221, 0, v221
    v_max_f32 v222, 0, v222
    ds_read_b128 v[32:35], v254 offset:384
    s_waitcnt lgkmcnt(3)
    v_mfma_f32_32x32x16_bf16 v[192:207], v[100:103], v[228:231], v[192:207]
    v_max_f32 v223, 0, v223
    v_cvt_pk_bf16_f32 v240, v208, v209
    v_cvt_pk_bf16_f32 v241, v210, v211
    ds_read_b128 v[36:39], v254 offset:416
    s_waitcnt lgkmcnt(3)
    v_mfma_f32_32x32x16_bf16 v[192:207], v[104:107], v[232:235], v[192:207]
    v_cvt_pk_bf16_f32 v242, v212, v213
    v_cvt_pk_bf16_f32 v243, v214, v215
    v_cvt_pk_bf16_f32 v244, v216, v217
    ds_read_b128 v[40:43], v254 offset:448
    s_waitcnt lgkmcnt(3)
    v_mfma_f32_32x32x16_bf16 v[192:207], v[108:111], v[236:239], v[192:207]
    v_cvt_pk_bf16_f32 v245, v218, v219
    v_cvt_pk_bf16_f32 v246, v220, v221
    v_cvt_pk_bf16_f32 v247, v222, v223
    ds_read_b128 v[44:47], v254 offset:480
    s_waitcnt lgkmcnt(3)
    v_mfma_f32_32x32x16_bf16 v[192:207], v[112:115], v[32:35], v[192:207]
    s_add_u32 s29, s25, 1
    s_and_b32 s29, s29, 3
    s_mul_i32 s44, s29, 114688
    s_add_u32 s44, s44, s49
    buffer_store_dwordx4 v[240:243], v3, s[4:7], s44 offen offset:0 sc1
    buffer_store_dwordx4 v[244:247], v3, s[4:7], s44 offen offset:1024 sc1
    s_waitcnt vmcnt(6)
    s_barrier
    ds_read_b128 v[224:227], v252 offset:33792
    s_waitcnt lgkmcnt(3)
    v_mfma_f32_32x32x16_bf16 v[192:207], v[116:119], v[36:39], v[192:207]
    s_add_u32 s29, s25, 3
    s_and_b32 s29, s29, 3
    s_mul_i32 s31, s29, 32768
    s_add_u32 s31, s31, s26
    s_add_u32 m0, s32, 16896
    s_nop 0
    buffer_load_dwordx4 v251, s[4:7], s31 offen sc1 lds
    ds_read_b128 v[228:231], v252 offset:33824
    s_waitcnt lgkmcnt(3)
    v_mfma_f32_32x32x16_bf16 v[192:207], v[120:123], v[40:43], v[192:207]
    ds_read_b128 v[232:235], v252 offset:33856
    s_waitcnt lgkmcnt(3)
    v_mfma_f32_32x32x16_bf16 v[192:207], v[124:127], v[44:47], v[192:207]
    s_add_u32 s31, s31, 2048
    s_add_u32 m0, s32, 17952
    s_nop 0
    buffer_load_dwordx4 v251, s[4:7], s31 offen sc1 lds
    ds_read_b128 v[236:239], v252 offset:33888
    s_waitcnt lgkmcnt(3)
    v_mfma_f32_32x32x16_bf16 v[192:207], v[128:131], v[224:227], v[192:207]
    ds_read_b128 v[32:35], v252 offset:33920
    s_waitcnt lgkmcnt(3)
    v_mfma_f32_32x32x16_bf16 v[192:207], v[132:135], v[228:231], v[192:207]
    s_add_u32 s31, s31, 2048
    s_add_u32 m0, s32, 19008
    s_nop 0
    buffer_load_dwordx4 v251, s[4:7], s31 offen sc1 lds
    ds_read_b128 v[36:39], v252 offset:33952
    s_waitcnt lgkmcnt(3)
    v_mfma_f32_32x32x16_bf16 v[192:207], v[136:139], v[232:235], v[192:207]
    ds_read_b128 v[40:43], v252 offset:33984
    s_waitcnt lgkmcnt(3)
    v_mfma_f32_32x32x16_bf16 v[192:207], v[140:143], v[236:239], v[192:207]
    s_add_u32 s31, s31, 2048
    s_add_u32 m0, s32, 20064
    s_nop 0
    buffer_load_dwordx4 v251, s[4:7], s31 offen sc1 lds
    ds_read_b128 v[44:47], v252 offset:34016
    s_waitcnt lgkmcnt(3)
    v_mfma_f32_32x32x16_bf16 v[192:207], v[144:147], v[32:35], v[192:207]
    ds_read_b128 v[224:227], v252 offset:34048
    s_waitcnt lgkmcnt(3)
    v_mfma_f32_32x32x16_bf16 v[192:207], v[148:151], v[36:39], v[192:207]
    ds_read_b128 v[228:231], v252 offset:34080
    s_waitcnt lgkmcnt(3)
    v_mfma_f32_32x32x16_bf16 v[192:207], v[152:155], v[40:43], v[192:207]
    ds_read_b128 v[232:235], v252 offset:34112
    s_waitcnt lgkmcnt(3)
    v_mfma_f32_32x32x16_bf16 v[192:207], v[156:159], v[44:47], v[192:207]
    ds_read_b128 v[236:239], v252 offset:34144
    s_waitcnt lgkmcnt(3)
    v_mfma_f32_32x32x16_bf16 v[192:207], v[160:163], v[224:227], v[192:207]
    ds_read_b128 v[32:35], v252 offset:34176
    s_waitcnt lgkmcnt(3)
    v_mfma_f32_32x32x16_bf16 v[192:207], v[164:167], v[228:231], v[192:207]
    ds_read_b128 v[36:39], v252 offset:34208
    s_waitcnt lgkmcnt(3)
    v_mfma_f32_32x32x16_bf16 v[192:207], v[168:171], v[232:235], v[192:207]
    ds_read_b128 v[40:43], v252 offset:34240
    s_waitcnt lgkmcnt(3)
    v_mfma_f32_32x32x16_bf16 v[192:207], v[172:175], v[236:239], v[192:207]
    ds_read_b128 v[44:47], v252 offset:34272
    s_waitcnt lgkmcnt(3)
    v_mfma_f32_32x32x16_bf16 v[192:207], v[176:179], v[32:35], v[192:207]
    s_waitcnt vmcnt(6)
    s_barrier
    ds_read_b128 v[224:227], v252 offset:0
    s_waitcnt lgkmcnt(3)
    v_mfma_f32_32x32x16_bf16 v[192:207], v[180:183], v[36:39], v[192:207]
    s_add_u32 m0, s30, 58880
    s_nop 0
    buffer_load_dwordx4 v4, s[16:19], s41 offen  lds
    s_add_u32 m0, s30, 59904
    s_add_u32 s29, s41, 8192
    buffer_load_dwordx4 v4, s[16:19], s29 offen  lds
    s_add_u32 s41, s41, 16384
    s_cmp_eq_u32 s41, s40
    s_cmov_b32 s41, s39
    ds_read_b128 v[228:231], v252 offset:32
    s_waitcnt lgkmcnt(3)
    v_mfma_f32_32x32x16_bf16 v[192:207], v[184:187], v[40:43], v[192:207]
    ds_read_b128 v[232:235], v252 offset:64
    s_waitcnt lgkmcnt(3)
    v_mfma_f32_32x32x16_bf16 v[192:207], v[188:191], v[44:47], v[192:207]
    s_add_u32 m0, s30, 67072
    s_nop 0
    buffer_load_dwordx4 v4, s[16:19], s41 offen  lds
    s_add_u32 m0, s30, 68096
    s_add_u32 s29, s41, 8192
    buffer_load_dwordx4 v4, s[16:19], s29 offen  lds
    s_add_u32 s41, s41, 16384
    s_cmp_eq_u32 s41, s40
    s_cmov_b32 s41, s39
    ds_read_b128 v[236:239], v252 offset:96
    s_waitcnt lgkmcnt(3)
    v_mfma_f32_32x32x16_bf16 v[208:223], v[64:67], v[224:227], 0
    ds_read_b128 v[32:35], v252 offset:128
    s_waitcnt lgkmcnt(3)
    v_mfma_f32_32x32x16_bf16 v[208:223], v[68:71], v[228:231], v[208:223]
    ds_read_b128 v[36:39], v252 offset:160
    s_waitcnt lgkmcnt(3)
    v_mfma_f32_32x32x16_bf16 v[208:223], v[72:75], v[232:235], v[208:223]
    ds_read_b128 v[40:43], v252 offset:192
    s_waitcnt lgkmcnt(3)
    v_mfma_f32_32x32x16_bf16 v[208:223], v[76:79], v[236:239], v[208:223]
    v_max_f32 v192, 0, v192
    v_max_f32 v193, 0, v193
    v_max_f32 v194, 0, v194
    ds_read_b128 v[44:47], v252 offset:224
    s_waitcnt lgkmcnt(3)
    v_mfma_f32_32x32x16_bf16 v[208:223], v[80:83], v[32:35], v[208:223]
    v_max_f32 v195, 0, v195
    v_max_f32 v196, 0, v196
    v_max_f32 v197, 0, v197
    ds_read_b128 v[224:227], v252 offset:256
    s_waitcnt lgkmcnt(3)
    v_mfma_f32_32x32x16_bf16 v[208:223], v[84:87], v[36:39], v[208:223]
    v_max_f32 v198, 0, v198
    v_max_f32 v199, 0, v199
    v_max_f32 v200, 0, v200
    ds_read_b128 v[228:231], v252 offset:288
    s_waitcnt lgkmcnt(3)
    v_mfma_f32_32x32x16_bf16 v[208:223], v[88:91], v[40:43], v[208:223]
    v_max_f32 v201, 0, v201
    v_max_f32 v202, 0, v202
    v_max_f32 v203, 0, v203
    ds_read_b128 v[232:235], v252 offset:320
    s_waitcnt lgkmcnt(3)
    v_mfma_f32_32x32x16_bf16 v[208:223], v[92:95], v[44:47], v[208:223]
    v_max_f32 v204, 0, v204
    v_max_f32 v205, 0, v205
    v_max_f32 v206, 0, v206
    ds_read_b128 v[236:239], v252 offset:352
    s_waitcnt lgkmcnt(3)
    v_mfma_f32_32x32x16_bf16 v[208:223], v[96:99], v[224:227], v[208:223]
    v_max_f32 v207, 0, v207
    v_cvt_pk_bf16_f32 v240, v192, v193
    v_cvt_pk_bf16_f32 v241, v194, v195
    ds_read_b128 v[32:35], v252 offset:384
    s_waitcnt lgkmcnt(3)
    v_mfma_f32_32x32x16_bf16 v[208:223], v[100:103], v[228:231], v[208:223]
    v_cvt_pk_bf16_f32 v242, v196, v197
    v_cvt_pk_bf16_f32 v243, v198, v199
    v_cvt_pk_bf16_f32 v244, v200, v201
    ds_read_b128 v[36:39], v252 offset:416
    s_waitcnt lgkmcnt(3)
    v_mfma_f32_32x32x16_bf16 v[208:223], v[104:107], v[232:235], v[208:223]
    v_cvt_pk_bf16_f32 v245, v202, v203
    v_cvt_pk_bf16_f32 v246, v204, v205
    v_cvt_pk_bf16_f32 v247, v206, v207
    ds_read_b128 v[40:43], v252 offset:448
    s_waitcnt lgkmcnt(3)
    v_mfma_f32_32x32x16_bf16 v[208:223], v[108:111], v[236:239], v[208:223]
    s_add_u32 s29, s25, 2
    s_and_b32 s29, s29, 3
    s_mul_i32 s44, s29, 114688
    s_add_u32 s44, s44, s49
    buffer_store_dwordx4 v[240:243], v3, s[4:7], s44 offen offset:0 sc1
    buffer_store_dwordx4 v[244:247], v3, s[4:7], s44 offen offset:1024 sc1
    ds_read_b128 v[44:47], v252 offset:480
    s_waitcnt lgkmcnt(3)
    v_mfma_f32_32x32x16_bf16 v[208:223], v[112:115], v[32:35], v[208:223]
    s_waitcnt vmcnt(6)
    s_barrier
    ds_read_b128 v[224:227], v252 offset:16896
    s_waitcnt lgkmcnt(3)
    v_mfma_f32_32x32x16_bf16 v[208:223], v[116:119], v[36:39], v[208:223]
    s_add_u32 m0, s30, 40960
    s_nop 0
    buffer_load_dwordx4 v4, s[16:19], s41 offen  lds
    s_add_u32 m0, s30, 41984
    s_add_u32 s29, s41, 8192
    buffer_load_dwordx4 v4, s[16:19], s29 offen  lds
    s_add_u32 s41, s41, 16384
    s_cmp_eq_u32 s41, s40
    s_cmov_b32 s41, s39
    ds_read_b128 v[228:231], v252 offset:16928
    s_waitcnt lgkmcnt(3)
    v_mfma_f32_32x32x16_bf16 v[208:223], v[120:123], v[40:43], v[208:223]
    ds_read_b128 v[232:235], v252 offset:16960
    s_waitcnt lgkmcnt(3)
    v_mfma_f32_32x32x16_bf16 v[208:223], v[124:127], v[44:47], v[208:223]
    ds_read_b128 v[236:239], v252 offset:16992
    s_waitcnt lgkmcnt(3)
    v_mfma_f32_32x32x16_bf16 v[208:223], v[128:131], v[224:227], v[208:223]
    ds_read_b128 v[32:35], v252 offset:17024
    s_waitcnt lgkmcnt(3)
    v_mfma_f32_32x32x16_bf16 v[208:223], v[132:135], v[228:231], v[208:223]
    ds_read_b128 v[36:39], v252 offset:17056
    s_waitcnt lgkmcnt(3)
    v_mfma_f32_32x32x16_bf16 v[208:223], v[136:139], v[232:235], v[208:223]
    ds_read_b128 v[40:43], v252 offset:17088
    s_waitcnt lgkmcnt(3)
    v_mfma_f32_32x32x16_bf16 v[208:223], v[140:143], v[236:239], v[208:223]
    ds_read_b128 v[44:47], v252 offset:17120
    s_waitcnt lgkmcnt(3)
    v_mfma_f32_32x32x16_bf16 v[208:223], v[144:147], v[32:35], v[208:223]
    ds_read_b128 v[224:227], v252 offset:17152
    s_waitcnt lgkmcnt(3)
    v_mfma_f32_32x32x16_bf16 v[208:223], v[148:151], v[36:39], v[208:223]
    ds_read_b128 v[228:231], v252 offset:17184
    s_waitcnt lgkmcnt(3)
    v_mfma_f32_32x32x16_bf16 v[208:223], v[152:155], v[40:43], v[208:223]
    ds_read_b128 v[232:235], v252 offset:17216
    s_waitcnt lgkmcnt(3)
    v_mfma_f32_32x32x16_bf16 v[208:223], v[156:159], v[44:47], v[208:223]
    ds_read_b128 v[236:239], v252 offset:17248
    s_waitcnt lgkmcnt(3)
    v_mfma_f32_32x32x16_bf16 v[208:223], v[160:163], v[224:227], v[208:223]
    ds_read_b128 v[32:35], v252 offset:17280
    s_waitcnt lgkmcnt(3)
    v_mfma_f32_32x32x16_bf16 v[208:223], v[164:167], v[228:231], v[208:223]
    ds_read_b128 v[36:39], v252 offset:17312
    s_waitcnt lgkmcnt(3)
    v_mfma_f32_32x32x16_bf16 v[208:223], v[168:171], v[232:235], v[208:223]
    ds_read_b128 v[40:43], v252 offset:17344
    s_waitcnt lgkmcnt(3)
    v_mfma_f32_32x32x16_bf16 v[208:223], v[172:175], v[236:239], v[208:223]
    ds_read_b128 v[44:47], v252 offset:17376
    s_waitcnt lgkmcnt(3)
    v_mfma_f32_32x32x16_bf16 v[208:223], v[176:179], v[32:35], v[208:223]
    s_barrier
    s_waitcnt lgkmcnt(2)
    v_mfma_f32_32x32x16_bf16 v[208:223], v[180:183], v[36:39], v[208:223]
    s_add_u32 m0, s30, 0
    s_nop 0
    buffer_load_dwordx4 v4, s[16:19], s41 offen  lds
    s_add_u32 m0, s30, 1024
    s_add_u32 s29, s41, 8192
    buffer_load_dwordx4 v4, s[16:19], s29 offen  lds
    s_add_u32 s41, s41, 16384
    s_cmp_eq_u32 s41, s40
    s_cmov_b32 s41, s39
    s_waitcnt lgkmcnt(1)
    v_mfma_f32_32x32x16_bf16 v[208:223], v[184:187], v[40:43], v[208:223]
    s_add_u32 m0, s30, 8192
    s_nop 0
    buffer_load_dwordx4 v4, s[16:19], s41 offen  lds
    s_add_u32 m0, s30, 9216
    s_add_u32 s29, s41, 8192
    buffer_load_dwordx4 v4, s[16:19], s29 offen  lds
    s_add_u32 s41, s41, 16384
    s_cmp_eq_u32 s41, s40
    s_cmov_b32 s41, s39
    s_waitcnt lgkmcnt(0)
    v_mfma_f32_32x32x16_bf16 v[208:223], v[188:191], v[44:47], v[208:223]
    s_nop 11
    v_max_f32 v208, 0, v208
    v_max_f32 v209, 0, v209
    v_max_f32 v210, 0, v210
    v_max_f32 v211, 0, v211
    v_max_f32 v212, 0, v212
    v_max_f32 v213, 0, v213
    v_max_f32 v214, 0, v214
    v_max_f32 v215, 0, v215
    v_max_f32 v216, 0, v216
    v_max_f32 v217, 0, v217
    v_max_f32 v218, 0, v218
    v_max_f32 v219, 0, v219
    v_max_f32 v220, 0, v220
    v_max_f32 v221, 0, v221
    v_max_f32 v222, 0, v222
    v_max_f32 v223, 0, v223
    v_cvt_pk_bf16_f32 v240, v208, v209
    v_cvt_pk_bf16_f32 v241, v210, v211
    v_cvt_pk_bf16_f32 v242, v212, v213
    v_cvt_pk_bf16_f32 v243, v214, v215
    v_cvt_pk_bf16_f32 v244, v216, v217
    v_cvt_pk_bf16_f32 v245, v218, v219
    v_cvt_pk_bf16_f32 v246, v220, v221
    v_cvt_pk_bf16_f32 v247, v222, v223
    s_add_u32 s29, s25, 3
    s_and_b32 s29, s29, 3
    s_mul_i32 s44, s29, 114688
    s_add_u32 s44, s44, s49
    buffer_store_dwordx4 v[240:243], v3, s[4:7], s44 offen offset:0 sc1
    buffer_store_dwordx4 v[244:247], v3, s[4:7], s44 offen offset:1024 sc1
    s_barrier
    s_add_u32 m0, s30, 16384
    s_nop 0
    buffer_load_dwordx4 v4, s[16:19], s41 offen  lds
    s_add_u32 m0, s30, 17408
    s_add_u32 s29, s41, 8192
    buffer_load_dwordx4 v4, s[16:19], s29 offen  lds
    s_add_u32 s41, s41, 16384
    s_cmp_eq_u32 s41, s40
    s_cmov_b32 s41, s39
    s_add_u32 m0, s30, 24576
    s_nop 0
    buffer_load_dwordx4 v4, s[16:19], s41 offen  lds
    s_add_u32 m0, s30, 25600
    s_add_u32 s29, s41, 8192
    buffer_load_dwordx4 v4, s[16:19], s29 offen  lds
    s_add_u32 s41, s41, 16384
    s_cmp_eq_u32 s41, s40
    s_cmov_b32 s41, s39
    s_lshl_b32 s29, s23, 7
    s_lshl_b32 s34, s24, 2
    s_add_u32 s29, s29, s34
    s_add_u32 s50, s29, 69632
    s_waitcnt vmcnt(4)
    s_barrier
    s_cmp_lg_u32 s20, 0
    s_cbranch_scc1 C_nopub
    s_mov_b64 exec, 1
    buffer_atomic_swap v26, v27, s[4:7], s50 offen sc1
    s_mov_b64 exec, -1
C_nopub:
    s_add_u32 m0, s30, 32768
    s_nop 0
    buffer_load_dwordx4 v4, s[16:19], s41 offen  lds
    s_add_u32 m0, s30, 33792
    s_add_u32 s29, s41, 8192
    buffer_load_dwordx4 v4, s[16:19], s29 offen  lds
    s_add_u32 s41, s41, 16384
    s_cmp_eq_u32 s41, s40
    s_cmov_b32 s41, s39
    s_branch C_g2
C_idle:
    s_mul_i32 s42, s36, 224
    s_mul_i32 s29, s20, 28
    s_add_u32 s42, s42, s29
    s_lshl_b32 s42, s42, 10
    s_add_u32 s42, s42, 12582912
    s_add_u32 s43, s42, 28672
    s_lshl_b32 s29, s38, 10
    s_add_u32 s48, s42, s29
    s_lshr_b32 s29, s20, 1
    s_mul_i32 s29, s29, 114688
    v_add_u32 v52, s29, v3
    s_xor_b32 s29, s29, 114688
    v_add_u32 v5, s29, v3
    s_and_b32 s31, s20, 1
    s_lshr_b32 s32, s20, 1
    s_lshl_b32 s33, s36, 6
    s_lshl_b32 s34, s32, 5
    s_add_u32 s33, s33, s34
    s_lshl_b32 s34, s37, 6
    s_lshl_b32 s35, s31, 5
    s_add_u32 s34, s34, s35
    s_lshl_b32 s35, s33, 10
    s_lshl_b32 s29, s34, 1
    s_add_u32 s94, s35, s29
    s_lshl_b32 s95, s34, 12
    s_lshl_b32 s29, s33, 1
    s_add_u32 s95, s95, s29
    s_add_u32 s95, s95, 10485760
    v_lshrrev_b32 v28, 2, v2
    v_and_b32 v10, 3, v2
    v_lshlrev_b32 v10, 4, v10
    v_lshl_add_u32 v28, v28, 12, v10
    v_bfe_u32 v10, v2, 2, 2
    v_and_b32 v11, 3, v2
    v_bfe_u32 v12, v2, 4, 1
    v_lshl_add_u32 v13, v7, 2, v10
    v_lshlrev_b32 v13, 7, v13
    v_lshl_add_u32 v13, v12, 5, v13
    v_lshl_add_u32 v13, v11, 3, v13
    v_add_u32 v13, s30, v13
    v_lshrrev_b32 v10, 1, v10
    v_xor_b32 v10, s31, v10
    v_lshl_add_u32 v14, v10, 6, v13
    v_xor_b32 v10, 1, v10
    v_lshl_add_u32 v15, v10, 6, v13
    v_add_u32 v16, 0x8000, v14
    v_add_u32 v17, 0x8000, v15
    s_lshr_b32 s45, s36, 1
    s_lshl_b32 s45, s45, 7
    s_add_u32 s45, s45, 69632
    s_lshl_b32 s46, s37, 7
    s_add_u32 s46, s46, 73728
    v_lshlrev_b32 v29, 2, v9
    s_mul_i32 s29, s20, 7
    s_lshr_b32 s29, s29, 1
    s_lshl_b32 s29, s29, 2
    v_min_u32 v30, 12, v29
    v_add_u32 v30, s29, v30
    v_bfe_u32 v10, v2, 2, 2
    v_lshl_add_u32 v10, v7, 2, v10
    v_lshlrev_b32 v10, 6, v10
    v_lshl_add_u32 v10, v12, 5, v10
    v_lshl_add_u32 v10, v11, 3, v10
    v_add_u32 v12, s30, v10
    v_add_u32 v13, 0x8000, v12
    v_add_u32 v10, s30, v3
    v_add_u32 v11, 0x8000, v10
    v_lshlrev_b32 v8, 10, v9
    v_lshl_add_u32 v8, v7, 4, v8
    v_mov_b32 v255, v52
    s_waitcnt lgkmcnt(0)
    s_mul_i32 s62, s62, 0x9e3779b1
    s_add_u32 s62, s62, 0x7f4a7c15
    v_mov_b32 v26, s62
    v_mov_b32 v27, 0
    s_lshr_b32 s97, s2, 4
    s_lshl_b32 s97, s97, 7
    s_and_b32 s29, s2, 15
    s_lshl_b32 s29, s29, 2
    s_add_u32 s97, s97, s29
    s_add_u32 s97, s97, 90112
    s_cmp_lg_u32 s20, 1
    s_cbranch_scc1 C_noidf
    s_sub_u32 s34, s22, 28
    s_lshl_b32 s34, s34, 3
    s_add_u32 s34, s34, s21
    s_lshr_b32 s29, s34, 1
    s_lshl_b32 s29, s29, 7
    s_and_b32 s34, s34, 1
    s_lshl_b32 s34, s34, 2
    s_add_u32 s34, s34, s29
    s_add_u32 s34, s34, 69688
    s_mov_b64 exec, 1
    buffer_store_dword v26, v27, s[4:7], s34 offen sc1
    s_mov_b64 exec, -1
C_noidf:
    s_lshl_b32 s35, s23, 7
    s_add_u32 s35, s35, 86016
    v_and_b32 v253, 15, v2
    v_lshlrev_b32 v253, 2, v253
    s_cmp_lg_u32 s20, 0
    s_cbranch_scc1 C_fi_ok
    s_mov_b32 s29, 0
C_fi_poll:
    buffer_load_dword v31, v253, s[4:7], s35 offen sc1
    s_add_u32 s29, s29, 1
    s_waitcnt vmcnt(0)
    v_cmp_ne_u32 vcc, v31, v26
    s_nop 3
    s_cbranch_vccz C_fi_ok
    s_cmp_gt_u32 s29, 200000
    s_cbranch_scc1 C_fi_ok
    s_sleep 16
    s_branch C_fi_poll
C_fi_ok:
    s_barrier
    s_sub_u32 s34, s22, 28
    s_lshl_b32 s34, s34, 2
    s_add_u32 s34, s34, s20
    s_mul_i32 s34, s34, 114688
    s_add_u32 s35, s34, 114688
    s_mul_i32 s29, s21, 14336
    s_add_u32 s33, s34, s29
    s_lshl_b32 s29, s20, 10
    s_mov_b32 m0, s29
    s_mov_b32 s32, 0
C_warm:
    s_waitcnt vmcnt(7)
    buffer_load_dwordx4 v3, s[16:19], s33 offen lds
    s_add_u32 s33, s33, 1024
    s_waitcnt vmcnt(7)
    buffer_load_dwordx4 v3, s[16:19], s33 offen lds
    s_add_u32 s33, s33, 1024
    s_cmp_eq_u32 s33, s35
    s_cmov_b32 s33, s34
    s_add_u32 s32, s32, 1
    s_cmp_lt_u32 s32, 40
    s_cbranch_scc1 C_warm
    s_waitcnt vmcnt(0)
    s_barrier
    s_add_u32 m0, s30, 50688
    s_nop 0
    buffer_load_dwordx4 v4, s[16:19], s41 offen  lds
    s_add_u32 m0, s30, 51712
    s_add_u32 s29, s41, 8192
    buffer_load_dwordx4 v4, s[16:19], s29 offen  lds
    s_add_u32 s41, s41, 16384
    s_cmp_eq_u32 s41, s40
    s_cmov_b32 s41, s39
    s_add_u32 m0, s30, 58880
    s_nop 0
    buffer_load_dwordx4 v4, s[16:19], s41 offen  lds
    s_add_u32 m0, s30, 59904
    s_add_u32 s29, s41, 8192
    buffer_load_dwordx4 v4, s[16:19], s29 offen  lds
    s_add_u32 s41, s41, 16384
    s_cmp_eq_u32 s41, s40
    s_cmov_b32 s41, s39
    s_add_u32 m0, s30, 67072
    s_nop 0
    buffer_load_dwordx4 v4, s[16:19], s41 offen  lds
    s_add_u32 m0, s30, 68096
    s_add_u32 s29, s41, 8192
    buffer_load_dwordx4 v4, s[16:19], s29 offen  lds
    s_add_u32 s41, s41, 16384
    s_cmp_eq_u32 s41, s40
    s_cmov_b32 s41, s39
    s_add_u32 m0, s30, 40960
    s_nop 0
    buffer_load_dwordx4 v4, s[16:19], s41 offen  lds
    s_add_u32 m0, s30, 41984
    s_add_u32 s29, s41, 8192
    buffer_load_dwordx4 v4, s[16:19], s29 offen  lds
    s_add_u32 s41, s41, 16384
    s_cmp_eq_u32 s41, s40
    s_cmov_b32 s41, s39
    s_add_u32 m0, s30, 0
    s_nop 0
    buffer_load_dwordx4 v4, s[16:19], s41 offen  lds
    s_add_u32 m0, s30, 1024
    s_add_u32 s29, s41, 8192
    buffer_load_dwordx4 v4, s[16:19], s29 offen  lds
    s_add_u32 s41, s41, 16384
    s_cmp_eq_u32 s41, s40
    s_cmov_b32 s41, s39
    s_add_u32 m0, s30, 8192
    s_nop 0
    buffer_load_dwordx4 v4, s[16:19], s41 offen  lds
    s_add_u32 m0, s30, 9216
    s_add_u32 s29, s41, 8192
    buffer_load_dwordx4 v4, s[16:19], s29 offen  lds
    s_add_u32 s41, s41, 16384
    s_cmp_eq_u32 s41, s40
    s_cmov_b32 s41, s39
    s_add_u32 m0, s30, 16384
    s_nop 0
    buffer_load_dwordx4 v4, s[16:19], s41 offen  lds
    s_add_u32 m0, s30, 17408
    s_add_u32 s29, s41, 8192
    buffer_load_dwordx4 v4, s[16:19], s29 offen  lds
    s_add_u32 s41, s41, 16384
    s_cmp_eq_u32 s41, s40
    s_cmov_b32 s41, s39
    s_add_u32 m0, s30, 24576
    s_nop 0
    buffer_load_dwordx4 v4, s[16:19], s41 offen  lds
    s_add_u32 m0, s30, 25600
    s_add_u32 s29, s41, 8192
    buffer_load_dwordx4 v4, s[16:19], s29 offen  lds
    s_add_u32 s41, s41, 16384
    s_cmp_eq_u32 s41, s40
    s_cmov_b32 s41, s39
    s_add_u32 m0, s30, 32768
    s_nop 0
    buffer_load_dwordx4 v4, s[16:19], s41 offen  lds
    s_add_u32 m0, s30, 33792
    s_add_u32 s29, s41, 8192
    buffer_load_dwordx4 v4, s[16:19], s29 offen  lds
    s_add_u32 s41, s41, 16384
    s_cmp_eq_u32 s41, s40
    s_cmov_b32 s41, s39
    s_waitcnt vmcnt(0) lgkmcnt(0)
C_g2:
    v_mov_b32 v1, v255
    s_mov_b32 s8, s56
    s_mov_b32 s9, s57
    s_mov_b32 s10, 2097152
    s_mov_b32 s11, 0x00020000
    ds_read_b64_tr_b16 v[64:65], v14 offset:50688
    ds_read_b64_tr_b16 v[66:67], v14 offset:51712
    ds_read_b64_tr_b16 v[68:69], v15 offset:50688
    ds_read_b64_tr_b16 v[70:71], v15 offset:51712
    ds_read_b64_tr_b16 v[72:73], v16 offset:26112
    ds_read_b64_tr_b16 v[74:75], v16 offset:27136
    ds_read_b64_tr_b16 v[76:77], v17 offset:26112
    ds_read_b64_tr_b16 v[78:79], v17 offset:27136
    s_waitcnt lgkmcnt(4)
    s_add_u32 m0, s30, 50688
    s_nop 0
    buffer_load_dwordx4 v4, s[16:19], s41 offen  lds
    s_add_u32 m0, s30, 51712
    s_add_u32 s29, s41, 8192
    buffer_load_dwordx4 v4, s[16:19], s29 offen  lds
    s_add_u32 s41, s41, 16384
    s_cmp_eq_u32 s41, s40
    s_cmov_b32 s41, s39
    ds_read_b64_tr_b16 v[80:81], v16 offset:34304
    ds_read_b64_tr_b16 v[82:83], v16 offset:35328
    ds_read_b64_tr_b16 v[84:85], v17 offset:34304
    ds_read_b64_tr_b16 v[86:87], v17 offset:35328
    s_waitcnt lgkmcnt(4)
    s_add_u32 m0, s30, 58880
    s_nop 0
    buffer_load_dwordx4 v4, s[16:19], s41 offen  lds
    s_add_u32 m0, s30, 59904
    s_add_u32 s29, s41, 8192
    buffer_load_dwordx4 v4, s[16:19], s29 offen  lds
    s_add_u32 s41, s41, 16384
    s_cmp_eq_u32 s41, s40
    s_cmov_b32 s41, s39
    ds_read_b64_tr_b16 v[88:89], v14 offset:40960
    ds_read_b64_tr_b16 v[90:91], v14 offset:41984
    ds_read_b64_tr_b16 v[92:93], v15 offset:40960
    ds_read_b64_tr_b16 v[94:95], v15 offset:41984
    s_waitcnt lgkmcnt(4)
    s_add_u32 m0, s30, 67072
    s_nop 0
    buffer_load_dwordx4 v4, s[16:19], s41 offen  lds
    s_add_u32 m0, s30, 68096
    s_add_u32 s29, s41, 8192
    buffer_load_dwordx4 v4, s[16:19], s29 offen  lds
    s_add_u32 s41, s41, 16384
    s_cmp_eq_u32 s41, s40
    s_cmov_b32 s41, s39
    ds_read_b64_tr_b16 v[96:97], v14 offset:0
    ds_read_b64_tr_b16 v[98:99], v14 offset:1024
    ds_read_b64_tr_b16 v[100:101], v15 offset:0
    ds_read_b64_tr_b16 v[102:103], v15 offset:1024
    s_waitcnt lgkmcnt(4)
    s_add_u32 m0, s30, 40960
    s_nop 0
    buffer_load_dwordx4 v4, s[16:19], s41 offen  lds
    s_add_u32 m0, s30, 41984
    s_add_u32 s29, s41, 8192
    buffer_load_dwordx4 v4, s[16:19], s29 offen  lds
    s_add_u32 s41, s41, 16384
    s_cmp_eq_u32 s41, s40
    s_cmov_b32 s41, s39
    ds_read_b64_tr_b16 v[104:105], v14 offset:8192
    ds_read_b64_tr_b16 v[106:107], v14 offset:9216
    ds_read_b64_tr_b16 v[108:109], v15 offset:8192
    ds_read_b64_tr_b16 v[110:111], v15 offset:9216
    s_waitcnt lgkmcnt(4)
    s_add_u32 m0, s30, 0
    s_nop 0
    buffer_load_dwordx4 v4, s[16:19], s41 offen  lds
    s_add_u32 m0, s30, 1024
    s_add_u32 s29, s41, 8192
    buffer_load_dwordx4 v4, s[16:19], s29 offen  lds
    s_add_u32 s41, s41, 16384
    s_cmp_eq_u32 s41, s40
    s_cmov_b32 s41, s39
    s_waitcnt vmcnt(14)
    ds_read_b64_tr_b16 v[112:113], v14 offset:16384
    ds_read_b64_tr_b16 v[114:115], v14 offset:17408
    ds_read_b64_tr_b16 v[116:117], v15 offset:16384
    ds_read_b64_tr_b16 v[118:119], v15 offset:17408
    s_waitcnt lgkmcnt(4)
    s_add_u32 m0, s30, 8192
    s_nop 0
    buffer_load_dwordx4 v4, s[16:19], s41 offen  lds
    s_add_u32 m0, s30, 9216
    s_add_u32 s29, s41, 8192
    buffer_load_dwordx4 v4, s[16:19], s29 offen  lds
    s_add_u32 s41, s41, 16384
    s_cmp_eq_u32 s41, s40
    s_cmov_b32 s41, s39
    s_waitcnt vmcnt(14)
    ds_read_b64_tr_b16 v[120:121], v14 offset:24576
    ds_read_b64_tr_b16 v[122:123], v14 offset:25600
    ds_read_b64_tr_b16 v[124:125], v15 offset:24576
    ds_read_b64_tr_b16 v[126:127], v15 offset:25600
    s_waitcnt lgkmcnt(4)
    s_add_u32 m0, s30, 16384
    s_nop 0
    buffer_load_dwordx4 v4, s[16:19], s41 offen  lds
    s_add_u32 m0, s30, 17408
    s_add_u32 s29, s41, 8192
    buffer_load_dwordx4 v4, s[16:19], s29 offen  lds
    s_add_u32 s41, s41, 16384
    s_cmp_eq_u32 s41, s40
    s_cmov_b32 s41, s39
    s_waitcnt vmcnt(14)
    ds_read_b64_tr_b16 v[128:129], v14 offset:32768
    ds_read_b64_tr_b16 v[130:131], v14 offset:33792
    ds_read_b64_tr_b16 v[132:133], v15 offset:32768
    ds_read_b64_tr_b16 v[134:135], v15 offset:33792
    s_waitcnt lgkmcnt(4)
    s_add_u32 m0, s30, 24576
    s_nop 0
    buffer_load_dwordx4 v4, s[16:19], s41 offen  lds
    s_add_u32 m0, s30, 25600
    s_add_u32 s29, s41, 8192
    buffer_load_dwordx4 v4, s[16:19], s29 offen  lds
    s_add_u32 s41, s41, 16384
    s_cmp_eq_u32 s41, s40
    s_cmov_b32 s41, s39
    s_waitcnt vmcnt(14)
    ds_read_b64_tr_b16 v[136:137], v14 offset:50688
    ds_read_b64_tr_b16 v[138:139], v14 offset:51712
    ds_read_b64_tr_b16 v[140:141], v15 offset:50688
    ds_read_b64_tr_b16 v[142:143], v15 offset:51712
    s_waitcnt lgkmcnt(4)
    s_add_u32 m0, s30, 32768
    s_nop 0
    buffer_load_dwordx4 v4, s[16:19], s41 offen  lds
    s_add_u32 m0, s30, 33792
    s_add_u32 s29, s41, 8192
    buffer_load_dwordx4 v4, s[16:19], s29 offen  lds
    s_add_u32 s41, s41, 16384
    s_cmp_eq_u32 s41, s40
    s_cmov_b32 s41, s39
    s_waitcnt vmcnt(14)
    ds_read_b64_tr_b16 v[144:145], v16 offset:26112
    ds_read_b64_tr_b16 v[146:147], v16 offset:27136
    ds_read_b64_tr_b16 v[148:149], v17 offset:26112
    ds_read_b64_tr_b16 v[150:151], v17 offset:27136
    s_waitcnt lgkmcnt(4)
    s_add_u32 m0, s30, 50688
    s_nop 0
    buffer_load_dwordx4 v4, s[16:19], s41 offen  lds
    s_add_u32 m0, s30, 51712
    s_add_u32 s29, s41, 8192
    buffer_load_dwordx4 v4, s[16:19], s29 offen  lds
    s_add_u32 s41, s41, 16384
    s_cmp_eq_u32 s41, s40
    s_cmov_b32 s41, s39
    s_waitcnt vmcnt(14)
    ds_read_b64_tr_b16 v[152:153], v16 offset:34304
    ds_read_b64_tr_b16 v[154:155], v16 offset:35328
    ds_read_b64_tr_b16 v[156:157], v17 offset:34304
    ds_read_b64_tr_b16 v[158:159], v17 offset:35328
    s_waitcnt lgkmcnt(4)
    s_add_u32 m0, s30, 58880
    s_nop 0
    buffer_load_dwordx4 v4, s[16:19], s41 offen  lds
    s_add_u32 m0, s30, 59904
    s_add_u32 s29, s41, 8192
    buffer_load_dwordx4 v4, s[16:19], s29 offen  lds
    s_add_u32 s41, s41, 16384
    s_cmp_eq_u32 s41, s40
    s_cmov_b32 s41, s39
    s_waitcnt vmcnt(14)
    ds_read_b64_tr_b16 v[160:161], v14 offset:40960
    ds_read_b64_tr_b16 v[162:163], v14 offset:41984
    ds_read_b64_tr_b16 v[164:165], v15 offset:40960
    ds_read_b64_tr_b16 v[166:167], v15 offset:41984
    s_waitcnt lgkmcnt(4)
    s_add_u32 m0, s30, 67072
    s_nop 0
    buffer_load_dwordx4 v4, s[16:19], s41 offen  lds
    s_add_u32 m0, s30, 68096
    s_add_u32 s29, s41, 8192
    buffer_load_dwordx4 v4, s[16:19], s29 offen  lds
    s_add_u32 s41, s41, 16384
    s_cmp_eq_u32 s41, s40
    s_cmov_b32 s41, s39
    s_waitcnt vmcnt(14)
    ds_read_b64_tr_b16 v[168:169], v14 offset:0
    ds_read_b64_tr_b16 v[170:171], v14 offset:1024
    ds_read_b64_tr_b16 v[172:173], v15 offset:0
    ds_read_b64_tr_b16 v[174:175], v15 offset:1024
    s_waitcnt lgkmcnt(4)
    s_add_u32 m0, s30, 40960
    s_nop 0
    buffer_load_dwordx4 v4, s[16:19], s41 offen  lds
    s_add_u32 m0, s30, 41984
    s_add_u32 s29, s41, 8192
    buffer_load_dwordx4 v4, s[16:19], s29 offen  lds
    s_add_u32 s41, s41, 16384
    s_cmp_eq_u32 s41, s40
    s_cmov_b32 s41, s39
    buffer_load_dword v31, v30, s[4:7], s45 offen sc1
    s_waitcnt vmcnt(15)
    ds_read_b64_tr_b16 v[176:177], v14 offset:8192
    ds_read_b64_tr_b16 v[178:179], v14 offset:9216
    ds_read_b64_tr_b16 v[180:181], v15 offset:8192
    ds_read_b64_tr_b16 v[182:183], v15 offset:9216
    s_waitcnt lgkmcnt(4)
    s_add_u32 m0, s30, 0
    s_nop 0
    buffer_load_dwordx4 v4, s[16:19], s41 offen  lds
    s_add_u32 m0, s30, 1024
    s_add_u32 s29, s41, 8192
    buffer_load_dwordx4 v4, s[16:19], s29 offen  lds
    s_add_u32 s41, s41, 16384
    s_cmp_eq_u32 s41, s40
    s_cmov_b32 s41, s39
    s_waitcnt vmcnt(15)
    ds_read_b64_tr_b16 v[184:185], v14 offset:16384
    ds_read_b64_tr_b16 v[186:187], v14 offset:17408
    ds_read_b64_tr_b16 v[188:189], v15 offset:16384
    ds_read_b64_tr_b16 v[190:191], v15 offset:17408
    s_waitcnt lgkmcnt(4)
    s_add_u32 m0, s30, 8192
    s_nop 0
    buffer_load_dwordx4 v4, s[16:19], s41 offen  lds
    s_add_u32 m0, s30, 9216
    s_add_u32 s29, s41, 8192
    buffer_load_dwordx4 v4, s[16:19], s29 offen  lds
    s_add_u32 s41, s41, 16384
    s_cmp_eq_u32 s41, s40
    s_cmov_b32 s41, s39
    s_waitcnt vmcnt(4)
    v_cmp_ne_u32 vcc, v31, v26
    s_nop 3
    s_cbranch_vccz C_fh_ok
    s_mov_b32 s29, 0
    s_sleep 6
C_fh_poll:
    buffer_load_dword v31, v30, s[4:7], s45 offen sc1
    s_add_u32 s29, s29, 1
    s_waitcnt vmcnt(0)
    v_cmp_ne_u32 vcc, v31, v26
    s_nop 3
    s_cbranch_vccz C_fh_ok
    s_cmp_gt_u32 s29, 200000
    s_cbranch_scc1 C_fh_ok
    s_sleep 6
    s_branch C_fh_poll
C_fh_ok:
    buffer_load_dwordx4 v[32:35], v1, s[4:7], s48 offen sc1
    buffer_load_dwordx4 v[36:39], v5, s[4:7], s48 offen sc1
    s_add_u32 s48, s48, 1024
    s_cmp_eq_u32 s48, s43
    s_cmov_b32 s48, s42
    buffer_load_dwordx4 v[40:43], v1, s[4:7], s48 offen sc1
    buffer_load_dwordx4 v[44:47], v5, s[4:7], s48 offen sc1
    s_add_u32 s48, s48, 1024
    s_cmp_eq_u32 s48, s43
    s_cmov_b32 s48, s42
    buffer_load_dwordx4 v[48:51], v1, s[4:7], s48 offen sc1
    buffer_load_dwordx4 v[52:55], v5, s[4:7], s48 offen sc1
    s_add_u32 s48, s48, 1024
    s_cmp_eq_u32 s48, s43
    s_cmov_b32 s48, s42
    buffer_load_dwordx4 v[56:59], v1, s[4:7], s48 offen sc1
    buffer_load_dwordx4 v[60:63], v5, s[4:7], s48 offen sc1
    s_add_u32 s48, s48, 1024
    s_cmp_eq_u32 s48, s43
    s_cmov_b32 s48, s42
    s_waitcnt lgkmcnt(0)
    s_add_u32 m0, s30, 16384
    s_nop 0
    buffer_load_dwordx4 v4, s[16:19], s41 offen  lds
    s_add_u32 m0, s30, 17408
    s_add_u32 s29, s41, 8192
    buffer_load_dwordx4 v4, s[16:19], s29 offen  lds
    s_add_u32 s41, s41, 16384
    s_cmp_eq_u32 s41, s40
    s_cmov_b32 s41, s39
    s_mov_b32 s47, 0xffff0000
    s_waitcnt vmcnt(8)
    v_mfma_f32_32x32x16_bf16 v[192:207], v[64:67], v[32:35], 0
    v_mfma_f32_32x32x16_bf16 v[208:223], v[68:71], v[32:35], 0
    buffer_load_dwordx4 v[32:35], v1, s[4:7], s48 offen sc1
    v_mfma_f32_32x32x16_bf16 v[224:239], v[64:67], v[36:39], 0
    v_mfma_f32_32x32x16_bf16 v[240:255], v[68:71], v[36:39], 0
    buffer_load_dwordx4 v[36:39], v5, s[4:7], s48 offen sc1
    s_add_u32 s48, s48, 1024
    s_cmp_eq_u32 s48, s43
    s_cmov_b32 s48, s42
    s_waitcnt vmcnt(8)
    v_mfma_f32_32x32x16_bf16 v[192:207], v[72:75], v[40:43], v[192:207]
    v_mfma_f32_32x32x16_bf16 v[208:223], v[76:79], v[40:43], v[208:223]
    buffer_load_dwordx4 v[40:43], v1, s[4:7], s48 offen sc1
    v_mfma_f32_32x32x16_bf16 v[224:239], v[72:75], v[44:47], v[224:239]
    v_mfma_f32_32x32x16_bf16 v[240:255], v[76:79], v[44:47], v[240:255]
    buffer_load_dwordx4 v[44:47], v5, s[4:7], s48 offen sc1
    s_add_u32 s48, s48, 1024
    s_cmp_eq_u32 s48, s43
    s_cmov_b32 s48, s42
    ds_read_b64_tr_b16 v[64:65], v14 offset:24576
    ds_read_b64_tr_b16 v[66:67], v14 offset:25600
    ds_read_b64_tr_b16 v[68:69], v15 offset:24576
    ds_read_b64_tr_b16 v[70:71], v15 offset:25600
    s_waitcnt vmcnt(8)
    s_waitcnt lgkmcnt(0)
    s_add_u32 m0, s30, 24576
    s_nop 0
    buffer_load_dwordx4 v4, s[16:19], s41 offen  lds
    s_add_u32 m0, s30, 25600
    s_add_u32 s29, s41, 8192
    buffer_load_dwordx4 v4, s[16:19], s29 offen  lds
    s_add_u32 s41, s41, 16384
    s_cmp_eq_u32 s41, s40
    s_cmov_b32 s41, s39
    v_mfma_f32_32x32x16_bf16 v[192:207], v[80:83], v[48:51], v[192:207]
    v_mfma_f32_32x32x16_bf16 v[208:223], v[84:87], v[48:51], v[208:223]
    buffer_load_dwordx4 v[48:51], v1, s[4:7], s48 offen sc1
    v_mfma_f32_32x32x16_bf16 v[224:239], v[80:83], v[52:55], v[224:239]
    v_mfma_f32_32x32x16_bf16 v[240:255], v[84:87], v[52:55], v[240:255]
    buffer_load_dwordx4 v[52:55], v5, s[4:7], s48 offen sc1
    s_add_u32 s48, s48, 1024
    s_cmp_eq_u32 s48, s43
    s_cmov_b32 s48, s42
    ds_read_b64_tr_b16 v[72:73], v14 offset:32768
    ds_read_b64_tr_b16 v[74:75], v14 offset:33792
    ds_read_b64_tr_b16 v[76:77], v15 offset:32768
    ds_read_b64_tr_b16 v[78:79], v15 offset:33792
    s_waitcnt vmcnt(10)
    s_waitcnt lgkmcnt(0)
    s_add_u32 m0, s30, 32768
    s_nop 0
    buffer_load_dwordx4 v4, s[16:19], s41 offen  lds
    s_add_u32 m0, s30, 33792
    s_add_u32 s29, s41, 8192
    buffer_load_dwordx4 v4, s[16:19], s29 offen  lds
    s_add_u32 s41, s41, 16384
    s_cmp_eq_u32 s41, s40
    s_cmov_b32 s41, s39
    v_mfma_f32_32x32x16_bf16 v[192:207], v[88:91], v[56:59], v[192:207]
    v_mfma_f32_32x32x16_bf16 v[208:223], v[92:95], v[56:59], v[208:223]
    buffer_load_dwordx4 v[56:59], v1, s[4:7], s48 offen sc1
    v_mfma_f32_32x32x16_bf16 v[224:239], v[88:91], v[60:63], v[224:239]
    v_mfma_f32_32x32x16_bf16 v[240:255], v[92:95], v[60:63], v[240:255]
    buffer_load_dwordx4 v[60:63], v5, s[4:7], s48 offen sc1
    s_add_u32 s48, s48, 1024
    s_cmp_eq_u32 s48, s43
    s_cmov_b32 s48, s42
    ds_read_b64_tr_b16 v[80:81], v14 offset:50688
    ds_read_b64_tr_b16 v[82:83], v14 offset:51712
    ds_read_b64_tr_b16 v[84:85], v15 offset:50688
    ds_read_b64_tr_b16 v[86:87], v15 offset:51712
    s_waitcnt vmcnt(10)
    s_waitcnt lgkmcnt(0)
    s_add_u32 m0, s30, 50688
    s_nop 0
    buffer_load_dwordx4 v4, s[16:19], s41 offen  lds
    s_add_u32 m0, s30, 51712
    s_add_u32 s29, s41, 8192
    buffer_load_dwordx4 v4, s[16:19], s29 offen  lds
    s_add_u32 s41, s41, 16384
    s_cmp_eq_u32 s41, s40
    s_cmov_b32 s41, s39
    v_mfma_f32_32x32x16_bf16 v[192:207], v[96:99], v[32:35], v[192:207]
    v_mfma_f32_32x32x16_bf16 v[208:223], v[100:103], v[32:35], v[208:223]
    buffer_load_dwordx4 v[32:35], v1, s[4:7], s48 offen sc1
    v_mfma_f32_32x32x16_bf16 v[224:239], v[96:99], v[36:39], v[224:239]
    v_mfma_f32_32x32x16_bf16 v[240:255], v[100:103], v[36:39], v[240:255]
    buffer_load_dwordx4 v[36:39], v5, s[4:7], s48 offen sc1
    s_add_u32 s48, s48, 1024
    s_cmp_eq_u32 s48, s43
    s_cmov_b32 s48, s42
    ds_read_b64_tr_b16 v[88:89], v16 offset:26112
    ds_read_b64_tr_b16 v[90:91], v16 offset:27136
    ds_read_b64_tr_b16 v[92:93], v17 offset:26112
    ds_read_b64_tr_b16 v[94:95], v17 offset:27136
    s_waitcnt vmcnt(12)
    v_mfma_f32_32x32x16_bf16 v[192:207], v[104:107], v[40:43], v[192:207]
    v_mfma_f32_32x32x16_bf16 v[208:223], v[108:111], v[40:43], v[208:223]
    buffer_load_dwordx4 v[40:43], v1, s[4:7], s48 offen sc1
    v_mfma_f32_32x32x16_bf16 v[224:239], v[104:107], v[44:47], v[224:239]
    v_mfma_f32_32x32x16_bf16 v[240:255], v[108:111], v[44:47], v[240:255]
    buffer_load_dwordx4 v[44:47], v5, s[4:7], s48 offen sc1
    s_add_u32 s48, s48, 1024
    s_cmp_eq_u32 s48, s43
    s_cmov_b32 s48, s42
    ds_read_b64_tr_b16 v[96:97], v16 offset:34304
    ds_read_b64_tr_b16 v[98:99], v16 offset:35328
    ds_read_b64_tr_b16 v[100:101], v17 offset:34304
    ds_read_b64_tr_b16 v[102:103], v17 offset:35328
    s_waitcnt vmcnt(10)
    v_mfma_f32_32x32x16_bf16 v[192:207], v[112:115], v[48:51], v[192:207]
    v_mfma_f32_32x32x16_bf16 v[208:223], v[116:119], v[48:51], v[208:223]
    buffer_load_dwordx4 v[48:51], v1, s[4:7], s48 offen sc1
    v_mfma_f32_32x32x16_bf16 v[224:239], v[112:115], v[52:55], v[224:239]
    v_mfma_f32_32x32x16_bf16 v[240:255], v[116:119], v[52:55], v[240:255]
    buffer_load_dwordx4 v[52:55], v5, s[4:7], s48 offen sc1
    s_add_u32 s48, s48, 1024
    s_cmp_eq_u32 s48, s43
    s_cmov_b32 s48, s42
    ds_read_b64_tr_b16 v[104:105], v14 offset:40960
    ds_read_b64_tr_b16 v[106:107], v14 offset:41984
    ds_read_b64_tr_b16 v[108:109], v15 offset:40960
    ds_read_b64_tr_b16 v[110:111], v15 offset:41984
    s_waitcnt vmcnt(8)
    v_mfma_f32_32x32x16_bf16 v[192:207], v[120:123], v[56:59], v[192:207]
    v_mfma_f32_32x32x16_bf16 v[208:223], v[124:127], v[56:59], v[208:223]
    buffer_load_dwordx4 v[56:59], v1, s[4:7], s48 offen sc1
    v_mfma_f32_32x32x16_bf16 v[224:239], v[120:123], v[60:63], v[224:239]
    v_mfma_f32_32x32x16_bf16 v[240:255], v[124:127], v[60:63], v[240:255]
    buffer_load_dwordx4 v[60:63], v5, s[4:7], s48 offen sc1
    s_add_u32 s48, s48, 1024
    s_cmp_eq_u32 s48, s43
    s_cmov_b32 s48, s42
    ds_read_b64_tr_b16 v[112:113], v14 offset:0
    ds_read_b64_tr_b16 v[114:115], v14 offset:1024
    ds_read_b64_tr_b16 v[116:117], v15 offset:0
    ds_read_b64_tr_b16 v[118:119], v15 offset:1024
    s_waitcnt vmcnt(6)
    v_mfma_f32_32x32x16_bf16 v[192:207], v[128:131], v[32:35], v[192:207]
    v_mfma_f32_32x32x16_bf16 v[208:223], v[132:135], v[32:35], v[208:223]
    buffer_load_dwordx4 v[32:35], v1, s[4:7], s48 offen sc1
    v_mfma_f32_32x32x16_bf16 v[224:239], v[128:131], v[36:39], v[224:239]
    v_mfma_f32_32x32x16_bf16 v[240:255], v[132:135], v[36:39], v[240:255]
    buffer_load_dwordx4 v[36:39], v5, s[4:7], s48 offen sc1
    s_add_u32 s48, s48, 1024
    s_cmp_eq_u32 s48, s43
    s_cmov_b32 s48, s42
    ds_read_b64_tr_b16 v[120:121], v14 offset:8192
    ds_read_b64_tr_b16 v[122:123], v14 offset:9216
    ds_read_b64_tr_b16 v[124:125], v15 offset:8192
    ds_read_b64_tr_b16 v[126:127], v15 offset:9216
    s_waitcnt vmcnt(6)
    v_mfma_f32_32x32x16_bf16 v[192:207], v[136:139], v[40:43], v[192:207]
    v_mfma_f32_32x32x16_bf16 v[208:223], v[140:143], v[40:43], v[208:223]
    buffer_load_dwordx4 v[40:43], v1, s[4:7], s48 offen sc1
    v_mfma_f32_32x32x16_bf16 v[224:239], v[136:139], v[44:47], v[224:239]
    v_mfma_f32_32x32x16_bf16 v[240:255], v[140:143], v[44:47], v[240:255]
    buffer_load_dwordx4 v[44:47], v5, s[4:7], s48 offen sc1
    s_add_u32 s48, s48, 1024
    s_cmp_eq_u32 s48, s43
    s_cmov_b32 s48, s42
    ds_read_b64_tr_b16 v[128:129], v14 offset:16384
    ds_read_b64_tr_b16 v[130:131], v14 offset:17408
    ds_read_b64_tr_b16 v[132:133], v15 offset:16384
    ds_read_b64_tr_b16 v[134:135], v15 offset:17408
    s_waitcnt vmcnt(6)
    v_mfma_f32_32x32x16_bf16 v[192:207], v[144:147], v[48:51], v[192:207]
    v_mfma_f32_32x32x16_bf16 v[208:223], v[148:151], v[48:51], v[208:223]
    buffer_load_dwordx4 v[48:51], v1, s[4:7], s48 offen sc1
    v_mfma_f32_32x32x16_bf16 v[224:239], v[144:147], v[52:55], v[224:239]
    v_mfma_f32_32x32x16_bf16 v[240:255], v[148:151], v[52:55], v[240:255]
    buffer_load_dwordx4 v[52:55], v5, s[4:7], s48 offen sc1
    s_add_u32 s48, s48, 1024
    s_cmp_eq_u32 s48, s43
    s_cmov_b32 s48, s42
    ds_read_b64_tr_b16 v[136:137], v14 offset:24576
    ds_read_b64_tr_b16 v[138:139], v14 offset:25600
    ds_read_b64_tr_b16 v[140:141], v15 offset:24576
    ds_read_b64_tr_b16 v[142:143], v15 offset:25600
    s_waitcnt vmcnt(6)
    v_mfma_f32_32x32x16_bf16 v[192:207], v[152:155], v[56:59], v[192:207]
    v_mfma_f32_32x32x16_bf16 v[208:223], v[156:159], v[56:59], v[208:223]
    buffer_load_dwordx4 v[56:59], v1, s[4:7], s48 offen sc1
    v_mfma_f32_32x32x16_bf16 v[224:239], v[152:155], v[60:63], v[224:239]
    v_mfma_f32_32x32x16_bf16 v[240:255], v[156:159], v[60:63], v[240:255]
    buffer_load_dwordx4 v[60:63], v5, s[4:7], s48 offen sc1
    s_add_u32 s48, s48, 1024
    s_cmp_eq_u32 s48, s43
    s_cmov_b32 s48, s42
    ds_read_b64_tr_b16 v[144:145], v14 offset:32768
    ds_read_b64_tr_b16 v[146:147], v14 offset:33792
    ds_read_b64_tr_b16 v[148:149], v15 offset:32768
    ds_read_b64_tr_b16 v[150:151], v15 offset:33792
    s_waitcnt vmcnt(6)
    v_mfma_f32_32x32x16_bf16 v[192:207], v[160:163], v[32:35], v[192:207]
    v_mfma_f32_32x32x16_bf16 v[208:223], v[164:167], v[32:35], v[208:223]
    buffer_load_dwordx4 v[32:35], v1, s[4:7], s48 offen sc1
    v_mfma_f32_32x32x16_bf16 v[224:239], v[160:163], v[36:39], v[224:239]
    v_mfma_f32_32x32x16_bf16 v[240:255], v[164:167], v[36:39], v[240:255]
    buffer_load_dwordx4 v[36:39], v5, s[4:7], s48 offen sc1
    s_add_u32 s48, s48, 1024
    s_cmp_eq_u32 s48, s43
    s_cmov_b32 s48, s42
    ds_read_b64_tr_b16 v[152:153], v14 offset:50688
    ds_read_b64_tr_b16 v[154:155], v14 offset:51712
    ds_read_b64_tr_b16 v[156:157], v15 offset:50688
    ds_read_b64_tr_b16 v[158:159], v15 offset:51712
    s_waitcnt vmcnt(6)
    v_mfma_f32_32x32x16_bf16 v[192:207], v[168:171], v[40:43], v[192:207]
    v_mfma_f32_32x32x16_bf16 v[208:223], v[172:175], v[40:43], v[208:223]
    buffer_load_dwordx4 v[40:43], v1, s[4:7], s48 offen sc1
    v_mfma_f32_32x32x16_bf16 v[224:239], v[168:171], v[44:47], v[224:239]
    v_mfma_f32_32x32x16_bf16 v[240:255], v[172:175], v[44:47], v[240:255]
    buffer_load_dwordx4 v[44:47], v5, s[4:7], s48 offen sc1
    s_add_u32 s48, s48, 1024
    s_cmp_eq_u32 s48, s43
    s_cmov_b32 s48, s42
    s_waitcnt vmcnt(6)
    v_mfma_f32_32x32x16_bf16 v[192:207], v[176:179], v[48:51], v[192:207]
    v_mfma_f32_32x32x16_bf16 v[208:223], v[180:183], v[48:51], v[208:223]
    buffer_load_dwordx4 v[48:51], v1, s[4:7], s48 offen sc1
    v_mfma_f32_32x32x16_bf16 v[224:239], v[176:179], v[52:55], v[224:239]
    v_mfma_f32_32x32x16_bf16 v[240:255], v[180:183], v[52:55], v[240:255]
    buffer_load_dwordx4 v[52:55], v5, s[4:7], s48 offen sc1
    s_add_u32 s48, s48, 1024
    s_cmp_eq_u32 s48, s43
    s_cmov_b32 s48, s42
    s_waitcnt vmcnt(6)
    v_mfma_f32_32x32x16_bf16 v[192:207], v[184:187], v[56:59], v[192:207]
    v_mfma_f32_32x32x16_bf16 v[208:223], v[188:191], v[56:59], v[208:223]
    buffer_load_dwordx4 v[56:59], v1, s[4:7], s48 offen sc1
    v_mfma_f32_32x32x16_bf16 v[224:239], v[184:187], v[60:63], v[224:239]
    v_mfma_f32_32x32x16_bf16 v[240:255], v[188:191], v[60:63], v[240:255]
    buffer_load_dwordx4 v[60:63], v5, s[4:7], s48 offen sc1
    s_add_u32 s48, s48, 1024
    s_cmp_eq_u32 s48, s43
    s_cmov_b32 s48, s42
    s_waitcnt vmcnt(6)
    v_mfma_f32_32x32x16_bf16 v[192:207], v[64:67], v[32:35], v[192:207]
    v_mfma_f32_32x32x16_bf16 v[208:223], v[68:71], v[32:35], v[208:223]
    buffer_load_dwordx4 v[32:35], v1, s[4:7], s48 offen sc1
    v_mfma_f32_32x32x16_bf16 v[224:239], v[64:67], v[36:39], v[224:239]
    v_mfma_f32_32x32x16_bf16 v[240:255], v[68:71], v[36:39], v[240:255]
    buffer_load_dwordx4 v[36:39], v5, s[4:7], s48 offen sc1
    s_add_u32 s48, s48, 1024
    s_cmp_eq_u32 s48, s43
    s_cmov_b32 s48, s42
    buffer_load_dword v31, v29, s[4:7], s46 offen sc1
    s_waitcnt vmcnt(7)
    v_mfma_f32_32x32x16_bf16 v[192:207], v[72:75], v[40:43], v[192:207]
    v_mfma_f32_32x32x16_bf16 v[208:223], v[76:79], v[40:43], v[208:223]
    buffer_load_dwordx4 v[40:43], v1, s[4:7], s48 offen sc1
    v_mfma_f32_32x32x16_bf16 v[224:239], v[72:75], v[44:47], v[224:239]
    v_mfma_f32_32x32x16_bf16 v[240:255], v[76:79], v[44:47], v[240:255]
    buffer_load_dwordx4 v[44:47], v5, s[4:7], s48 offen sc1
    s_add_u32 s48, s48, 1024
    s_cmp_eq_u32 s48, s43
    s_cmov_b32 s48, s42
    s_waitcnt vmcnt(7)
    v_mfma_f32_32x32x16_bf16 v[192:207], v[80:83], v[48:51], v[192:207]
    v_mfma_f32_32x32x16_bf16 v[208:223], v[84:87], v[48:51], v[208:223]
    buffer_load_dwordx4 v[48:51], v1, s[4:7], s48 offen sc1
    v_mfma_f32_32x32x16_bf16 v[224:239], v[80:83], v[52:55], v[224:239]
    v_mfma_f32_32x32x16_bf16 v[240:255], v[84:87], v[52:55], v[240:255]
    buffer_load_dwordx4 v[52:55], v5, s[4:7], s48 offen sc1
    s_add_u32 s48, s48, 1024
    s_cmp_eq_u32 s48, s43
    s_cmov_b32 s48, s42
    s_waitcnt vmcnt(7)
    s_waitcnt lgkmcnt(15)
    v_mfma_f32_32x32x16_bf16 v[192:207], v[88:91], v[56:59], v[192:207]
    v_mfma_f32_32x32x16_bf16 v[208:223], v[92:95], v[56:59], v[208:223]
    buffer_load_dwordx4 v[56:59], v1, s[4:7], s48 offen sc1
    v_mfma_f32_32x32x16_bf16 v[224:239], v[88:91], v[60:63], v[224:239]
    v_mfma_f32_32x32x16_bf16 v[240:255], v[92:95], v[60:63], v[240:255]
    buffer_load_dwordx4 v[60:63], v5, s[4:7], s48 offen sc1
    s_add_u32 s48, s48, 1024
    s_cmp_eq_u32 s48, s43
    s_cmov_b32 s48, s42
    buffer_load_dwordx4 v[160:163], v1, s[4:7], s48 offen sc1
    buffer_load_dwordx4 v[164:167], v5, s[4:7], s48 offen sc1
    s_add_u32 s48, s48, 1024
    s_cmp_eq_u32 s48, s43
    s_cmov_b32 s48, s42
    s_waitcnt vmcnt(9)
    v_mfma_f32_32x32x16_bf16 v[192:207], v[96:99], v[32:35], v[192:207]
    v_mfma_f32_32x32x16_bf16 v[208:223], v[100:103], v[32:35], v[208:223]
    buffer_load_dwordx4 v[168:171], v1, s[4:7], s48 offen sc1
    v_mfma_f32_32x32x16_bf16 v[224:239], v[96:99], v[36:39], v[224:239]
    v_mfma_f32_32x32x16_bf16 v[240:255], v[100:103], v[36:39], v[240:255]
    buffer_load_dwordx4 v[172:175], v5, s[4:7], s48 offen sc1
    s_add_u32 s48, s48, 1024
    s_cmp_eq_u32 s48, s43
    s_cmov_b32 s48, s42
    buffer_load_dwordx4 v[176:179], v1, s[4:7], s48 offen sc1
    buffer_load_dwordx4 v[180:183], v5, s[4:7], s48 offen sc1
    s_add_u32 s48, s48, 1024
    s_cmp_eq_u32 s48, s43
    s_cmov_b32 s48, s42
    s_waitcnt vmcnt(12)
    v_cmp_ne_u32 vcc, v31, v26
    s_nop 3
    s_cbranch_vccz C_fz_ok
    s_mov_b32 s29, 0
    s_sleep 6
C_fz_poll:
    buffer_load_dword v31, v29, s[4:7], s46 offen sc1
    s_add_u32 s29, s29, 1
    s_waitcnt vmcnt(0)
    v_cmp_ne_u32 vcc, v31, v26
    s_nop 3
    s_cbranch_vccz C_fz_ok
    s_cmp_gt_u32 s29, 200000
    s_cbranch_scc1 C_fz_ok
    s_sleep 6
    s_branch C_fz_poll
C_fz_ok:
    s_waitcnt lgkmcnt(0)
    s_add_u32 m0, s30, 50688
    s_nop 0
    buffer_load_dwordx4 v28, s[4:7], s95 offen sc1 lds
    s_add_u32 m0, s30, 51712
    s_add_u32 s95, s95, 65536
    buffer_load_dwordx4 v28, s[4:7], s95 offen sc1 lds
    s_waitcnt vmcnt(12)
    v_mfma_f32_32x32x16_bf16 v[192:207], v[104:107], v[40:43], v[192:207]
    v_mfma_f32_32x32x16_bf16 v[208:223], v[108:111], v[40:43], v[208:223]
    buffer_load_dwordx4 v[184:187], v1, s[4:7], s48 offen sc1
    v_mfma_f32_32x32x16_bf16 v[224:239], v[104:107], v[44:47], v[224:239]
    v_mfma_f32_32x32x16_bf16 v[240:255], v[108:111], v[44:47], v[240:255]
    buffer_load_dwordx4 v[188:191], v5, s[4:7], s48 offen sc1
    s_add_u32 s48, s48, 1024
    s_cmp_eq_u32 s48, s43
    s_cmov_b32 s48, s42
    s_waitcnt vmcnt(12)
    v_mfma_f32_32x32x16_bf16 v[192:207], v[112:115], v[48:51], v[192:207]
    v_mfma_f32_32x32x16_bf16 v[208:223], v[116:119], v[48:51], v[208:223]
    v_mfma_f32_32x32x16_bf16 v[224:239], v[112:115], v[52:55], v[224:239]
    v_mfma_f32_32x32x16_bf16 v[240:255], v[116:119], v[52:55], v[240:255]
    s_waitcnt vmcnt(10)
    v_mfma_f32_32x32x16_bf16 v[192:207], v[120:123], v[56:59], v[192:207]
    v_mfma_f32_32x32x16_bf16 v[208:223], v[124:127], v[56:59], v[208:223]
    v_mfma_f32_32x32x16_bf16 v[224:239], v[120:123], v[60:63], v[224:239]
    v_mfma_f32_32x32x16_bf16 v[240:255], v[124:127], v[60:63], v[240:255]
    s_waitcnt lgkmcnt(0)
    s_waitcnt vmcnt(0)
    ds_read_b64_tr_b16 v[64:65], v12 offset:50688
    ds_read_b64_tr_b16 v[66:67], v12 offset:51200
    ds_read_b64_tr_b16 v[68:69], v12 offset:51712
    ds_read_b64_tr_b16 v[70:71], v12 offset:52224
    v_mfma_f32_32x32x16_bf16 v[208:223], v[132:135], v[160:163], v[208:223]
    s_xor_b32 s29, s20, 1
    s_lshl_b32 s29, s29, 11
    v_add_u32 v14, s29, v3
    s_xor_b32 s29, s20, 2
    s_lshl_b32 s29, s29, 11
    v_add_u32 v15, s29, v3
    s_xor_b32 s29, s20, 3
    v_mfma_f32_32x32x16_bf16 v[208:223], v[140:143], v[168:171], v[208:223]
    s_lshl_b32 s29, s29, 11
    v_add_u32 v16, s29, v3
    s_waitcnt lgkmcnt(0)
    v_lshlrev_b32 v48, 16, v64
    v_and_b32 v49, s47, v64
    v_lshlrev_b32 v50, 16, v65
    v_and_b32 v51, s47, v65
    v_mfma_f32_32x32x16_bf16 v[208:223], v[148:151], v[176:179], v[208:223]
    v_lshlrev_b32 v52, 16, v66
    v_and_b32 v53, s47, v66
    v_lshlrev_b32 v54, 16, v67
    v_and_b32 v55, s47, v67
    v_lshlrev_b32 v56, 16, v68
    v_and_b32 v57, s47, v68
    v_lshlrev_b32 v58, 16, v69
    v_mfma_f32_32x32x16_bf16 v[208:223], v[156:159], v[184:187], v[208:223]
    v_and_b32 v59, s47, v69
    v_lshlrev_b32 v60, 16, v70
    v_and_b32 v61, s47, v70
    v_lshlrev_b32 v62, 16, v71
    v_and_b32 v63, s47, v71
    s_waitcnt vmcnt(0)
    v_lshlrev_b32 v32, 16, v18
    v_mfma_f32_32x32x16_bf16 v[224:239], v[128:131], v[164:167], v[224:239]
    v_and_b32 v33, s47, v18
    v_lshlrev_b32 v34, 16, v19
    v_and_b32 v35, s47, v19
    v_lshlrev_b32 v36, 16, v20
    v_and_b32 v37, s47, v20
    v_lshlrev_b32 v38, 16, v21
    v_mfma_f32_32x32x16_bf16 v[224:239], v[136:139], v[172:175], v[224:239]
    v_and_b32 v39, s47, v21
    v_lshlrev_b32 v40, 16, v22
    v_and_b32 v41, s47, v22
    v_lshlrev_b32 v42, 16, v23
    v_and_b32 v43, s47, v23
    v_lshlrev_b32 v44, 16, v24
    v_mfma_f32_32x32x16_bf16 v[224:239], v[144:147], v[180:183], v[224:239]
    v_and_b32 v45, s47, v24
    v_lshlrev_b32 v46, 16, v25
    v_and_b32 v47, s47, v25
    ds_write_b128 v10, v[208:211] offset:0
    ds_write_b128 v10, v[212:215] offset:1024
    v_mfma_f32_32x32x16_bf16 v[224:239], v[152:155], v[188:191], v[224:239]
    v_add_f32 v32, v32, v48
    v_add_f32 v33, v33, v49
    v_add_f32 v34, v34, v50
    ds_write_b128 v10, v[216:219] offset:8192
    ds_write_b128 v10, v[220:223] offset:9216
    v_mfma_f32_32x32x16_bf16 v[240:255], v[132:135], v[164:167], v[240:255]
    v_add_f32 v35, v35, v51
    v_add_f32 v36, v36, v52
    v_add_f32 v37, v37, v53
    v_add_f32 v38, v38, v54
    v_add_f32 v39, v39, v55
    v_add_f32 v40, v40, v56
    v_mfma_f32_32x32x16_bf16 v[240:255], v[140:143], v[172:175], v[240:255]
    v_add_f32 v41, v41, v57
    v_add_f32 v42, v42, v58
    v_add_f32 v43, v43, v59
    v_add_f32 v44, v44, v60
    v_add_f32 v45, v45, v61
    v_add_f32 v46, v46, v62
    v_mfma_f32_32x32x16_bf16 v[240:255], v[148:151], v[180:183], v[240:255]
    v_add_f32 v47, v47, v63
    v_cvt_pk_bf16_f32 v18, v32, v33
    v_cvt_pk_bf16_f32 v19, v34, v35
    ds_write_b128 v10, v[224:227] offset:16384
    ds_write_b128 v10, v[228:231] offset:17408
    v_mfma_f32_32x32x16_bf16 v[240:255], v[156:159], v[188:191], v[240:255]
    v_cvt_pk_bf16_f32 v20, v36, v37
    v_cvt_pk_bf16_f32 v21, v38, v39
    v_cvt_pk_bf16_f32 v22, v40, v41
    ds_write_b128 v10, v[232:235] offset:24576
    ds_write_b128 v10, v[236:239] offset:25600
    v_mfma_f32_32x32x16_bf16 v[192:207], v[128:131], v[160:163], v[192:207]
    v_cvt_pk_bf16_f32 v23, v42, v43
    v_cvt_pk_bf16_f32 v24, v44, v45
    v_cvt_pk_bf16_f32 v25, v46, v47
    v_lshlrev_b32 v32, 16, v18
    v_and_b32 v33, s47, v18
    v_lshlrev_b32 v34, 16, v19
    v_mfma_f32_32x32x16_bf16 v[192:207], v[136:139], v[168:171], v[192:207]
    v_and_b32 v35, s47, v19
    v_lshlrev_b32 v36, 16, v20
    v_and_b32 v37, s47, v20
    v_lshlrev_b32 v38, 16, v21
    v_and_b32 v39, s47, v21
    v_lshlrev_b32 v40, 16, v22
    v_mfma_f32_32x32x16_bf16 v[192:207], v[144:147], v[176:179], v[192:207]
    v_and_b32 v41, s47, v22
    v_lshlrev_b32 v42, 16, v23
    v_and_b32 v43, s47, v23
    ds_write_b128 v10, v[240:243] offset:32768
    ds_write_b128 v10, v[244:247] offset:33792
    v_mfma_f32_32x32x16_bf16 v[192:207], v[152:155], v[184:187], v[192:207]
    v_lshlrev_b32 v44, 16, v24
    v_and_b32 v45, s47, v24
    v_lshlrev_b32 v46, 16, v25
    ds_write_b128 v10, v[248:251] offset:40960
    ds_write_b128 v10, v[252:255] offset:41984
    s_waitcnt lgkmcnt(0)
    s_barrier
    ds_read_b128 v[208:211], v14 offset:0
    ds_read_b128 v[212:215], v14 offset:1024
    ds_read_b128 v[216:219], v14 offset:8192
    ds_read_b128 v[220:223], v14 offset:9216
    ds_read_b128 v[224:227], v15 offset:16384
    ds_read_b128 v[228:231], v15 offset:17408
    ds_read_b128 v[232:235], v15 offset:24576
    ds_read_b128 v[236:239], v15 offset:25600
    ds_read_b128 v[240:243], v16 offset:32768
    ds_read_b128 v[244:247], v16 offset:33792
    ds_read_b128 v[248:251], v16 offset:40960
    ds_read_b128 v[252:255], v16 offset:41984
    v_and_b32 v47, s47, v25
    s_waitcnt lgkmcnt(8)
    v_pk_add_f32 v[192:193], v[192:193], v[208:209]
    v_pk_add_f32 v[194:195], v[194:195], v[210:211]
    v_pk_add_f32 v[196:197], v[196:197], v[212:213]
    v_pk_add_f32 v[198:199], v[198:199], v[214:215]
    v_pk_add_f32 v[200:201], v[200:201], v[216:217]
    v_pk_add_f32 v[202:203], v[202:203], v[218:219]
    v_pk_add_f32 v[204:205], v[204:205], v[220:221]
    v_pk_add_f32 v[206:207], v[206:207], v[222:223]
    s_waitcnt lgkmcnt(0)
    v_pk_add_f32 v[224:225], v[224:225], v[240:241]
    v_pk_add_f32 v[226:227], v[226:227], v[242:243]
    v_pk_add_f32 v[228:229], v[228:229], v[244:245]
    v_pk_add_f32 v[230:231], v[230:231], v[246:247]
    v_pk_add_f32 v[232:233], v[232:233], v[248:249]
    v_pk_add_f32 v[234:235], v[234:235], v[250:251]
    v_pk_add_f32 v[236:237], v[236:237], v[252:253]
    v_pk_add_f32 v[238:239], v[238:239], v[254:255]
    v_pk_add_f32 v[192:193], v[192:193], v[224:225]
    v_pk_add_f32 v[194:195], v[194:195], v[226:227]
    v_pk_add_f32 v[196:197], v[196:197], v[228:229]
    v_pk_add_f32 v[198:199], v[198:199], v[230:231]
    v_pk_add_f32 v[200:201], v[200:201], v[232:233]
    v_pk_add_f32 v[202:203], v[202:203], v[234:235]
    v_pk_add_f32 v[204:205], v[204:205], v[236:237]
    v_pk_add_f32 v[206:207], v[206:207], v[238:239]
    v_cvt_pk_bf16_f32 v64, v192, v193
    v_cvt_pk_bf16_f32 v65, v194, v195
    v_cvt_pk_bf16_f32 v66, v196, v197
    v_cvt_pk_bf16_f32 v67, v198, v199
    v_cvt_pk_bf16_f32 v68, v200, v201
    v_cvt_pk_bf16_f32 v69, v202, v203
    v_cvt_pk_bf16_f32 v70, v204, v205
    v_cvt_pk_bf16_f32 v71, v206, v207
    v_lshlrev_b32 v48, 16, v64
    v_and_b32 v49, s47, v64
    v_lshlrev_b32 v50, 16, v65
    v_and_b32 v51, s47, v65
    v_lshlrev_b32 v52, 16, v66
    v_and_b32 v53, s47, v66
    v_lshlrev_b32 v54, 16, v67
    v_and_b32 v55, s47, v67
    v_lshlrev_b32 v56, 16, v68
    v_and_b32 v57, s47, v68
    v_lshlrev_b32 v58, 16, v69
    v_and_b32 v59, s47, v69
    v_lshlrev_b32 v60, 16, v70
    v_and_b32 v61, s47, v70
    v_lshlrev_b32 v62, 16, v71
    v_and_b32 v63, s47, v71
    v_pk_add_f32 v[32:33], v[32:33], v[48:49]
    v_pk_add_f32 v[34:35], v[34:35], v[50:51]
    v_pk_add_f32 v[36:37], v[36:37], v[52:53]
    v_pk_add_f32 v[38:39], v[38:39], v[54:55]
    v_pk_add_f32 v[40:41], v[40:41], v[56:57]
    v_pk_add_f32 v[42:43], v[42:43], v[58:59]
    v_pk_add_f32 v[44:45], v[44:45], v[60:61]
    v_pk_add_f32 v[46:47], v[46:47], v[62:63]
    v_cvt_pk_bf16_f32 v192, v32, v33
    v_cvt_pk_bf16_f32 v193, v34, v35
    v_cvt_pk_bf16_f32 v194, v36, v37
    v_cvt_pk_bf16_f32 v195, v38, v39
    v_cvt_pk_bf16_f32 v196, v40, v41
    v_cvt_pk_bf16_f32 v197, v42, v43
    v_cvt_pk_bf16_f32 v198, v44, v45
    v_cvt_pk_bf16_f32 v199, v46, v47
    v_permlane32_swap_b32 v192, v194
    v_permlane32_swap_b32 v193, v195
    v_permlane32_swap_b32 v196, v198
    v_permlane32_swap_b32 v197, v199
    buffer_store_dwordx4 v[192:195], v8, s[8:11], s94 offen offset:0 nt
    buffer_store_dwordx4 v[196:199], v8, s[8:11], s94 offen offset:32 nt
    s_endpgm
S_role:
    s_setprio 3
    s_sub_u32 s3, s2, 256
    v_lshrrev_b32 v1, 6, v0
    v_and_b32 v2, 63, v0
    v_readfirstlane_b32 s20, v1
    s_nop 1
    s_lshr_b32 s21, s20, 1
    s_and_b32 s22, s20, 1
    s_lshl_b32 s23, s3, 1
    s_add_u32 s23, s23, s21
    s_and_b32 s24, s3, 7
    s_lshr_b32 s25, s3, 3
    s_lshl_b32 s16, s24, 8
    s_lshl_b32 s17, s25, 3
    s_add_u32 s16, s16, s17
    s_lshl_b32 s17, s20, 1
    s_add_u32 s16, s16, s17
    s_lshl_b32 s18, s16, 10
    s_lshl_b32 s26, s24, 1
    s_lshr_b32 s27, s25, 4
    s_add_u32 s26, s26, s27
    s_and_b32 s27, s25, 15
    v_lshlrev_b32 v3, 4, v2
    v_lshrrev_b32 v4, 2, v2
    v_and_b32 v5, 3, v2
    v_lshlrev_b32 v5, 4, v5
    v_lshl_add_u32 v4, v4, 10, v5
    s_lshl_b32 s28, s26, 17
    s_lshl_b32 s29, s20, 15
    s_add_u32 s28, s28, s29
    s_lshl_b32 s29, s27, 6
    s_add_u32 s28, s28, s29
    s_lshl_b32 s29, s20, 11
    s_add_u32 s29, s29, 68608
    s_lshl_b32 s30, s23, 8
    s_lshl_b32 s31, s22, 7
    s_add_u32 s30, s30, s31
    v_lshlrev_b32 v6, 1, v2
    v_add_u32 v6, s30, v6
    s_lshl_b32 s31, s23, 1
    v_mov_b32 v7, s31
    s_lshl_b32 s19, s3, 2
    s_waitcnt lgkmcnt(0)
    s_add_u32 s60, s60, 0
    s_addc_u32 s61, s61, 0
    s_load_dword s62, s[60:61], 81920
    s_load_dword s63, s[48:49], s19
    s_mov_b32 s8, s36
    s_mov_b32 s9, s37
    s_mov_b32 s10, 2097152
    s_mov_b32 s11, 0x00020000
    s_mov_b32 s4, s60
    s_mov_b32 s5, s61
    s_mov_b32 s6, 268435456
    s_mov_b32 s7, 0x00020000
    buffer_load_dwordx4 v[8:11], v3, s[8:11], s18 offen nt
    buffer_load_dwordx4 v[12:15], v3, s[8:11], s18 offen offset:1024 nt
    global_load_ushort v60, v6, s[38:39] nt
    global_load_ushort v61, v6, s[40:41] nt
    global_load_ushort v62, v6, s[42:43] nt
    global_load_ushort v63, v6, s[44:45] nt
    global_load_ushort v64, v7, s[46:47]
    s_add_u32 m0, s29, 0
    s_add_u32 s31, s28, 0
    buffer_load_dwordx4 v4, s[8:11], s31 offen nt lds
    s_add_u32 m0, s29, 1024
    s_add_u32 s31, s28, 16384
    buffer_load_dwordx4 v4, s[8:11], s31 offen nt lds
    s_mov_b32 s19, 0xffff0000
    s_mov_b32 s12, 1069066811
    s_mov_b32 s13, 1042479491
    s_mul_i32 s14, s20, 1088
    s_add_u32 s14, s14, 53312
    v_lshrrev_b32 v205, 4, v2
    v_and_b32 v206, 15, v2
    v_lshl_add_u32 v207, v205, 4, v3
    v_add_u32 v207, s14, v207
    v_mul_u32_u24 v208, 272, v205
    v_add_u32 v208, s14, v208
    v_add_u32 v20, 1, v206
    v_cvt_f32_u32 v204, v20
    v_lshlrev_b32 v209, 6, v205
    v_bfe_u32 v21, v2, 2, 2
    v_lshl_add_u32 v21, v205, 3, v21
    v_lshlrev_b32 v21, 6, v21
    v_and_b32 v22, 3, v2
    v_lshl_add_u32 v21, v22, 3, v21
    v_add_u32 v210, s29, v21
    v_mul_u32_u24 v211, 4224, v206
    v_lshl_add_u32 v211, v205, 4, v211
    s_lshl_b32 s28, s20, 11
    s_add_u32 s28, s28, 57664
    v_add_u32 v212, s28, v3
    s_xor_b32 s28, s20, 1
    s_lshl_b32 s28, s28, 11
    s_add_u32 s28, s28, 57664
    v_add_u32 v213, s28, v3
    s_lshl_b32 s28, s20, 3
    s_add_u32 s28, s28, 65856
    v_mov_b32 v214, s28
    v_xor_b32 v248, 8, v214
    v_and_b32 v20, 15, v20
    v_lshlrev_b32 v20, 5, v20
    v_lshl_add_u32 v20, v205, 3, v20
    s_mul_i32 s32, s21, 1344
    s_add_u32 s32, s32, 65920
    v_add_u32 v215, s32, v20
    s_mul_i32 s33, s21, 17408
    s_mul_i32 s34, s21, 9216
    s_add_u32 s34, s34, 34880
    v_and_b32 v27, 127, v0
    v_lshlrev_b32 v30, 3, v27
    v_add_u32 v216, s34, v30
    v_sub_u32 v30, 1008, v30
    v_add_u32 v217, s34, v30
    v_lshlrev_b32 v218, 2, v206
    s_mul_i32 s35, s22, 2080
    s_add_u32 s28, s35, s33
    v_add_u32 v219, s28, v3
    s_mul_i32 s24, s23, 4224
    s_add_u32 s24, s24, s35
    s_add_u32 s24, s24, 2097152
    v_and_b32 v20, 3, v2
    v_bfe_u32 v21, v2, 2, 2
    v_mul_u32_u24 v20, 4160, v20
    v_add_u32 v21, v21, v205
    v_lshl_add_u32 v20, v21, 4, v20
    s_lshl_b32 s31, s22, 8
    s_add_u32 s28, s33, s31
    v_add_u32 v220, s28, v20
    v_and_b32 v21, 1, v2
    v_bfe_u32 v22, v2, 1, 3
    v_mul_u32_u24 v20, 4640, v21
    v_lshl_add_u32 v20, v205, 4, v20
    v_lshlrev_b32 v23, 6, v22
    v_sub_u32 v20, v20, v23
    s_add_u32 s28, s34, s31
    s_add_u32 s28, s28, 448
    v_add_u32 v221, s28, v20
    v_lshlrev_b32 v23, 5, v22
    v_lshl_add_u32 v23, v21, 2, v23
    v_lshl_add_u32 v23, v205, 3, v23
    v_lshlrev_b32 v223, 1, v23
    s_lshl_b32 s28, s22, 11
    s_add_u32 s28, s28, s33
    s_add_u32 s28, s28, 12528
    v_add_u32 v222, s28, v223
    s_lshl_b32 s28, s20, 12
    s_add_u32 s28, s28, 53312
    v_add_u32 v224, s28, v3
    s_xor_b32 s28, s20, 1
    s_lshl_b32 s28, s28, 12
    s_add_u32 s28, s28, 53312
    v_add_u32 v225, s28, v3
    v_mov_b32 v227, 0
    v_mov_b32 v228, 1.0
    v_mov_b32 v229, 0
    v_mov_b32 v230, 0
    v_mov_b32 v231, 0
    v_lshlrev_b32 v4, 2, v27
    s_sub_u32 s28, s32, 34042
    s_mov_b32 s31, 0xffff
    v_add_u32 v66, 0, v4
    v_add_u32 v67, 1, v4
    v_add_u32 v68, 2, v4
    v_add_u32 v69, 3, v4
    v_add_u32 v70, 512, v4
    v_add_u32 v71, 513, v4
    v_add_u32 v72, 514, v4
    v_add_u32 v73, 515, v4
    v_add_u32 v74, 1024, v4
    v_add_u32 v75, 1025, v4
    v_add_u32 v76, 1026, v4
    v_add_u32 v77, 1027, v4
    v_add_u32 v78, 1536, v4
    v_add_u32 v79, 1537, v4
    v_add_u32 v80, 1538, v4
    v_add_u32 v81, 1539, v4
    v_cvt_f32_u32 v232, v66
    v_cvt_f32_u32 v233, v67
    v_cvt_f32_u32 v234, v68
    v_cvt_f32_u32 v235, v69
    v_cvt_f32_u32 v236, v70
    v_cvt_f32_u32 v237, v71
    v_cvt_f32_u32 v238, v72
    v_cvt_f32_u32 v239, v73
    v_cvt_f32_u32 v240, v74
    v_cvt_f32_u32 v241, v75
    v_cvt_f32_u32 v242, v76
    v_cvt_f32_u32 v243, v77
    v_cvt_f32_u32 v244, v78
    v_cvt_f32_u32 v245, v79
    v_cvt_f32_u32 v246, v80
    v_cvt_f32_u32 v247, v81
    v_cvt_pk_bf16_f32 v232, v232, v233
    v_cvt_pk_bf16_f32 v234, v234, v235
    v_cvt_pk_bf16_f32 v236, v236, v237
    v_cvt_pk_bf16_f32 v238, v238, v239
    v_cvt_pk_bf16_f32 v240, v240, v241
    v_cvt_pk_bf16_f32 v242, v242, v243
    v_cvt_pk_bf16_f32 v244, v244, v245
    v_cvt_pk_bf16_f32 v246, v246, v247
    v_lshrrev_b32 v233, 16, v232
    v_and_b32 v232, s31, v232
    v_lshrrev_b32 v235, 16, v234
    v_and_b32 v234, s31, v234
    v_lshrrev_b32 v237, 16, v236
    v_and_b32 v236, s31, v236
    v_lshrrev_b32 v239, 16, v238
    v_and_b32 v238, s31, v238
    v_lshrrev_b32 v241, 16, v240
    v_and_b32 v240, s31, v240
    v_lshrrev_b32 v243, 16, v242
    v_and_b32 v242, s31, v242
    v_lshrrev_b32 v245, 16, v244
    v_and_b32 v244, s31, v244
    v_lshrrev_b32 v247, 16, v246
    v_and_b32 v246, s31, v246
    v_min_u32 v66, 128, v66
    v_add_u32 v66, 0x4280, v66
    v_max_u32 v232, v232, v66
    v_min_u32 v67, 128, v67
    v_add_u32 v67, 0x4280, v67
    v_max_u32 v233, v233, v67
    v_min_u32 v68, 128, v68
    v_add_u32 v68, 0x4280, v68
    v_max_u32 v234, v234, v68
    v_min_u32 v69, 128, v69
    v_add_u32 v69, 0x4280, v69
    v_max_u32 v235, v235, v69
    v_lshl_add_u32 v232, v232, 1, s28
    v_lshl_add_u32 v233, v233, 1, s28
    v_lshl_add_u32 v234, v234, 1, s28
    v_lshl_add_u32 v235, v235, 1, s28
    v_lshl_add_u32 v236, v236, 1, s28
    v_lshl_add_u32 v237, v237, 1, s28
    v_lshl_add_u32 v238, v238, 1, s28
    v_lshl_add_u32 v239, v239, 1, s28
    v_lshl_add_u32 v240, v240, 1, s28
    v_lshl_add_u32 v241, v241, 1, s28
    v_lshl_add_u32 v242, v242, 1, s28
    v_lshl_add_u32 v243, v243, 1, s28
    v_lshl_add_u32 v244, v244, 1, s28
    v_lshl_add_u32 v245, v245, 1, s28
    v_lshl_add_u32 v246, v246, 1, s28
    v_lshl_add_u32 v247, v247, 1, s28
    v_cmp_gt_u32 vcc, 69, v27
    s_nop 1
    s_and_saveexec_b64 s[30:31], vcc
    ds_write_b64 v216, v[230:231] offset:4088
    s_mov_b64 exec, -1
    v_cmp_gt_u32 vcc, 56, v27
    s_nop 1
    s_and_saveexec_b64 s[30:31], vcc
    ds_write_b64 v216, v[230:231] offset:8736
    s_mov_b64 exec, -1
    v_mov_b32 v40, 0x3b000000
    s_waitcnt lgkmcnt(0)
    s_mul_i32 s62, s62, 0x9e3779b1
    s_add_u32 s62, s62, 0x7f4a7c15
    v_mov_b32 v226, s62
    v_mov_b32 v41, s62
    v_mov_b32 v43, s62
    s_lshl_b32 s17, s16, 3
    s_add_u32 s17, s17, 0
    s_add_u32 s18, s18, 20971520
    v_mov_b32 v39, 0x3b000000
    s_waitcnt vmcnt(7)
    v_lshlrev_b32 v16, 16, v8
    v_and_b32 v17, s19, v8
    v_lshlrev_b32 v18, 16, v9
    v_and_b32 v19, s19, v9
    v_lshlrev_b32 v20, 16, v10
    v_and_b32 v21, s19, v10
    v_lshlrev_b32 v22, 16, v11
    v_and_b32 v23, s19, v11
    v_lshlrev_b32 v24, 16, v12
    v_and_b32 v25, s19, v12
    v_lshlrev_b32 v26, 16, v13
    v_and_b32 v27, s19, v13
    v_lshlrev_b32 v28, 16, v14
    v_and_b32 v29, s19, v14
    v_lshlrev_b32 v30, 16, v15
    v_and_b32 v31, s19, v15
    v_pk_add_f32 v[44:45], v[16:17], v[18:19]
    v_pk_add_f32 v[52:53], v[24:25], v[26:27]
    v_pk_add_f32 v[46:47], v[20:21], v[22:23]
    v_pk_add_f32 v[54:55], v[28:29], v[30:31]
    v_pk_add_f32 v[44:45], v[44:45], v[46:47]
    v_pk_add_f32 v[52:53], v[52:53], v[54:55]
    v_add_f32 v32, v44, v45
    v_add_f32 v33, v52, v53
    s_nop 0
    v_add_f32_dpp v32, v32, v32 row_shr:1 row_mask:0xf bank_mask:0xf bound_ctrl:0
    v_add_f32_dpp v33, v33, v33 row_shr:1 row_mask:0xf bank_mask:0xf bound_ctrl:0
    s_nop 0
    v_add_f32_dpp v32, v32, v32 row_shr:2 row_mask:0xf bank_mask:0xf bound_ctrl:0
    v_add_f32_dpp v33, v33, v33 row_shr:2 row_mask:0xf bank_mask:0xf bound_ctrl:0
    s_nop 0
    v_add_f32_dpp v32, v32, v32 row_shr:4 row_mask:0xf bank_mask:0xf bound_ctrl:0
    v_add_f32_dpp v33, v33, v33 row_shr:4 row_mask:0xf bank_mask:0xf bound_ctrl:0
    s_nop 0
    v_add_f32_dpp v32, v32, v32 row_shr:8 row_mask:0xf bank_mask:0xf bound_ctrl:0
    v_add_f32_dpp v33, v33, v33 row_shr:8 row_mask:0xf bank_mask:0xf bound_ctrl:0
    s_nop 0
    v_add_f32_dpp v32, v32, v32 row_bcast:15 row_mask:0xa bank_mask:0xf
    v_add_f32_dpp v33, v33, v33 row_bcast:15 row_mask:0xa bank_mask:0xf
    s_nop 0
    v_add_f32_dpp v32, v32, v32 row_bcast:31 row_mask:0xc bank_mask:0xf
    v_add_f32_dpp v33, v33, v33 row_bcast:31 row_mask:0xc bank_mask:0xf
    v_readlane_b32 s30, v32, 63
    v_readlane_b32 s31, v33, 63
    s_nop 0
    v_mul_f32 v34, s30, v39
    v_mul_f32 v36, s31, v39
    v_pk_add_f32 v[44:45], v[16:17], v[34:35] op_sel_hi:[1,0] neg_lo:[0,1] neg_hi:[0,1]
    v_pk_add_f32 v[52:53], v[24:25], v[36:37] op_sel_hi:[1,0] neg_lo:[0,1] neg_hi:[0,1]
    v_pk_add_f32 v[46:47], v[18:19], v[34:35] op_sel_hi:[1,0] neg_lo:[0,1] neg_hi:[0,1]
    v_pk_add_f32 v[54:55], v[26:27], v[36:37] op_sel_hi:[1,0] neg_lo:[0,1] neg_hi:[0,1]
    v_pk_add_f32 v[48:49], v[20:21], v[34:35] op_sel_hi:[1,0] neg_lo:[0,1] neg_hi:[0,1]
    v_pk_add_f32 v[56:57], v[28:29], v[36:37] op_sel_hi:[1,0] neg_lo:[0,1] neg_hi:[0,1]
    v_pk_add_f32 v[50:51], v[22:23], v[34:35] op_sel_hi:[1,0] neg_lo:[0,1] neg_hi:[0,1]
    v_pk_add_f32 v[58:59], v[30:31], v[36:37] op_sel_hi:[1,0] neg_lo:[0,1] neg_hi:[0,1]
    v_pk_mul_f32 v[8:9], v[44:45], v[44:45]
    v_pk_mul_f32 v[12:13], v[52:53], v[52:53]
    v_pk_fma_f32 v[8:9], v[46:47], v[46:47], v[8:9]
    v_pk_fma_f32 v[12:13], v[54:55], v[54:55], v[12:13]
    v_pk_fma_f32 v[8:9], v[48:49], v[48:49], v[8:9]
    v_pk_fma_f32 v[12:13], v[56:57], v[56:57], v[12:13]
    v_pk_fma_f32 v[8:9], v[50:51], v[50:51], v[8:9]
    v_pk_fma_f32 v[12:13], v[58:59], v[58:59], v[12:13]
    v_add_f32 v32, v8, v9
    v_add_f32 v33, v12, v13
    s_nop 0
    v_add_f32_dpp v32, v32, v32 row_shr:1 row_mask:0xf bank_mask:0xf bound_ctrl:0
    v_add_f32_dpp v33, v33, v33 row_shr:1 row_mask:0xf bank_mask:0xf bound_ctrl:0
    s_nop 0
    v_add_f32_dpp v32, v32, v32 row_shr:2 row_mask:0xf bank_mask:0xf bound_ctrl:0
    v_add_f32_dpp v33, v33, v33 row_shr:2 row_mask:0xf bank_mask:0xf bound_ctrl:0
    s_nop 0
    v_add_f32_dpp v32, v32, v32 row_shr:4 row_mask:0xf bank_mask:0xf bound_ctrl:0
    v_add_f32_dpp v33, v33, v33 row_shr:4 row_mask:0xf bank_mask:0xf bound_ctrl:0
    s_nop 0
    v_add_f32_dpp v32, v32, v32 row_shr:8 row_mask:0xf bank_mask:0xf bound_ctrl:0
    v_add_f32_dpp v33, v33, v33 row_shr:8 row_mask:0xf bank_mask:0xf bound_ctrl:0
    s_nop 0
    v_add_f32_dpp v32, v32, v32 row_bcast:15 row_mask:0xa bank_mask:0xf
    v_add_f32_dpp v33, v33, v33 row_bcast:15 row_mask:0xa bank_mask:0xf
    s_nop 0
    v_add_f32_dpp v32, v32, v32 row_bcast:31 row_mask:0xc bank_mask:0xf
    v_add_f32_dpp v33, v33, v33 row_bcast:31 row_mask:0xc bank_mask:0xf
    v_readlane_b32 s30, v32, 63
    v_readlane_b32 s31, v33, 63
    v_cvt_pk_bf16_f32 v34, v34, v34
    v_lshlrev_b32 v34, 16, v34
    v_cvt_pk_bf16_f32 v36, v36, v36
    v_lshlrev_b32 v36, 16, v36
    v_mul_f32 v35, s30, v39
    v_mul_f32 v37, s31, v39
    v_cvt_pk_bf16_f32 v35, v35, v35
    v_lshlrev_b32 v35, 16, v35
    v_cvt_pk_bf16_f32 v37, v37, v37
    v_lshlrev_b32 v37, 16, v37
    v_add_f32 v35, 0x3727c5ac, v35
    v_add_f32 v37, 0x3727c5ac, v37
    v_cvt_pk_bf16_f32 v35, v35, v35
    v_lshlrev_b32 v35, 16, v35
    v_cvt_pk_bf16_f32 v37, v37, v37
    v_lshlrev_b32 v37, 16, v37
    v_sqrt_f32 v35, v35
    v_sqrt_f32 v37, v37
    v_pk_add_f32 v[44:45], v[16:17], v[34:35] op_sel_hi:[1,0] neg_lo:[0,1] neg_hi:[0,1]
    v_pk_add_f32 v[52:53], v[24:25], v[36:37] op_sel_hi:[1,0] neg_lo:[0,1] neg_hi:[0,1]
    v_pk_add_f32 v[46:47], v[18:19], v[34:35] op_sel_hi:[1,0] neg_lo:[0,1] neg_hi:[0,1]
    v_pk_add_f32 v[54:55], v[26:27], v[36:37] op_sel_hi:[1,0] neg_lo:[0,1] neg_hi:[0,1]
    v_pk_add_f32 v[48:49], v[20:21], v[34:35] op_sel_hi:[1,0] neg_lo:[0,1] neg_hi:[0,1]
    v_pk_add_f32 v[56:57], v[28:29], v[36:37] op_sel_hi:[1,0] neg_lo:[0,1] neg_hi:[0,1]
    v_pk_add_f32 v[50:51], v[22:23], v[34:35] op_sel_hi:[1,0] neg_lo:[0,1] neg_hi:[0,1]
    v_pk_add_f32 v[58:59], v[30:31], v[36:37] op_sel_hi:[1,0] neg_lo:[0,1] neg_hi:[0,1]
    v_cvt_pk_bf16_f32 v40, v35, v34
    v_cvt_pk_bf16_f32 v42, v37, v36
    s_mov_b64 exec, 1
    buffer_store_dwordx4 v[40:43], v227, s[4:7], s17 offen sc1
    s_mov_b64 exec, -1
    v_lshlrev_b32 v35, 16, v40
    v_lshlrev_b32 v37, 16, v42
    v_rcp_f32 v35, v35
    v_rcp_f32 v37, v37
    v_cvt_pk_bf16_f32 v8, v44, v45
    v_cvt_pk_bf16_f32 v9, v46, v47
    v_cvt_pk_bf16_f32 v10, v48, v49
    v_cvt_pk_bf16_f32 v11, v50, v51
    v_cvt_pk_bf16_f32 v12, v52, v53
    v_cvt_pk_bf16_f32 v13, v54, v55
    v_cvt_pk_bf16_f32 v14, v56, v57
    v_cvt_pk_bf16_f32 v15, v58, v59
    v_lshlrev_b32 v44, 16, v8
    v_and_b32 v45, s19, v8
    v_lshlrev_b32 v46, 16, v9
    v_and_b32 v47, s19, v9
    v_lshlrev_b32 v48, 16, v10
    v_and_b32 v49, s19, v10
    v_lshlrev_b32 v50, 16, v11
    v_and_b32 v51, s19, v11
    v_lshlrev_b32 v52, 16, v12
    v_and_b32 v53, s19, v12
    v_lshlrev_b32 v54, 16, v13
    v_and_b32 v55, s19, v13
    v_lshlrev_b32 v56, 16, v14
    v_and_b32 v57, s19, v14
    v_lshlrev_b32 v58, 16, v15
    v_and_b32 v59, s19, v15
    v_pk_mul_f32 v[44:45], v[44:45], v[34:35] op_sel:[0,1] op_sel_hi:[1,1]
    v_pk_mul_f32 v[52:53], v[52:53], v[36:37] op_sel:[0,1] op_sel_hi:[1,1]
    v_pk_mul_f32 v[46:47], v[46:47], v[34:35] op_sel:[0,1] op_sel_hi:[1,1]
    v_pk_mul_f32 v[54:55], v[54:55], v[36:37] op_sel:[0,1] op_sel_hi:[1,1]
    v_pk_mul_f32 v[48:49], v[48:49], v[34:35] op_sel:[0,1] op_sel_hi:[1,1]
    v_pk_mul_f32 v[56:57], v[56:57], v[36:37] op_sel:[0,1] op_sel_hi:[1,1]
    v_pk_mul_f32 v[50:51], v[50:51], v[34:35] op_sel:[0,1] op_sel_hi:[1,1]
    v_pk_mul_f32 v[58:59], v[58:59], v[36:37] op_sel:[0,1] op_sel_hi:[1,1]
    v_cvt_pk_bf16_f32 v8, v44, v45
    v_cvt_pk_bf16_f32 v9, v46, v47
    v_cvt_pk_bf16_f32 v10, v48, v49
    v_cvt_pk_bf16_f32 v11, v50, v51
    v_cvt_pk_bf16_f32 v12, v52, v53
    v_cvt_pk_bf16_f32 v13, v54, v55
    v_cvt_pk_bf16_f32 v14, v56, v57
    v_cvt_pk_bf16_f32 v15, v58, v59
    buffer_store_dwordx4 v[8:11], v3, s[4:7], s18 offen sc1
    buffer_store_dwordx4 v[12:15], v3, s[4:7], s18 offen offset:1024 sc1
    s_waitcnt vmcnt(5)
    v_lshlrev_b32 v60, 16, v60
    v_lshlrev_b32 v61, 16, v61
    v_lshlrev_b32 v62, 16, v62
    v_lshlrev_b32 v63, 16, v63
    v_lshlrev_b32 v64, 16, v64
    v_mul_f32 v60, s12, v60
    v_mul_f32 v64, s12, v64
    v_exp_f32 v60, v60
    v_exp_f32 v64, v64
    v_cvt_pk_bf16_f32 v60, v60, v60
    v_lshlrev_b32 v60, 16, v60
    v_cvt_pk_bf16_f32 v64, v64, v64
    v_lshlrev_b32 v64, 16, v64
    v_max_f32 v21, |v62|, |v63|
    v_mul_f32 v16, v60, v64
    v_mul_f32 v17, v61, v64
    v_mul_f32 v16, s12, v16
    v_sub_f32 v16, 0, v16
    v_mul_f32 v17, s13, v17
    v_mov_b32 v20, v62
    v_max_f32_dpp v21, v21, v21 row_shr:1 row_mask:0xf bank_mask:0xf bound_ctrl:0
    s_nop 0
    v_add_f32_dpp v20, v20, v20 row_shr:1 row_mask:0xf bank_mask:0xf bound_ctrl:0
    v_max_f32_dpp v21, v21, v21 row_shr:2 row_mask:0xf bank_mask:0xf bound_ctrl:0
    s_nop 0
    v_add_f32_dpp v20, v20, v20 row_shr:2 row_mask:0xf bank_mask:0xf bound_ctrl:0
    v_max_f32_dpp v21, v21, v21 row_shr:4 row_mask:0xf bank_mask:0xf bound_ctrl:0
    s_nop 0
    v_add_f32_dpp v20, v20, v20 row_shr:4 row_mask:0xf bank_mask:0xf bound_ctrl:0
    v_max_f32_dpp v21, v21, v21 row_shr:8 row_mask:0xf bank_mask:0xf bound_ctrl:0
    s_nop 0
    v_add_f32_dpp v20, v20, v20 row_shr:8 row_mask:0xf bank_mask:0xf bound_ctrl:0
    v_max_f32_dpp v21, v21, v21 row_bcast:15 row_mask:0xa bank_mask:0xf
    s_nop 0
    v_add_f32_dpp v20, v20, v20 row_bcast:15 row_mask:0xa bank_mask:0xf
    v_max_f32_dpp v21, v21, v21 row_bcast:31 row_mask:0xc bank_mask:0xf
    s_nop 0
    v_add_f32_dpp v20, v20, v20 row_bcast:31 row_mask:0xc bank_mask:0xf
    v_readlane_b32 s14, v21, 63
    v_readlane_b32 s15, v20, 63
    s_nop 0
    v_frexp_exp_i32_f32 v22, s14
    v_sub_u32 v23, 0, v22
    v_ldexp_f32 v18, v62, v23
    v_ldexp_f32 v19, v63, v23
    ds_write_b128 v207, v[16:19]
    v_add_f32 v200, v64, v64
    v_mov_b32 v201, v22
    v_mov_b32 v21, s15
    v_mov_b32 v202, s15
    v_mov_b32 v203, v22
    ds_write_b64 v214, v[202:203]
    s_waitcnt lgkmcnt(0)
    ds_read_b128 v[32:35], v208 offset:0
    ds_read_b128 v[36:39], v208 offset:16
    ds_read_b128 v[40:43], v208 offset:32
    ds_read_b128 v[44:47], v208 offset:48
    ds_read_b128 v[48:51], v208 offset:64
    ds_read_b128 v[52:55], v208 offset:80
    ds_read_b128 v[56:59], v208 offset:96
    ds_read_b128 v[60:63], v208 offset:112
    s_waitcnt lgkmcnt(4)
    ds_read_b128 v[64:67], v208 offset:128
    ds_read_b128 v[68:71], v208 offset:144
    ds_read_b128 v[72:75], v208 offset:160
    ds_read_b128 v[76:79], v208 offset:176
    ds_read_b128 v[80:83], v208 offset:192
    ds_read_b128 v[84:87], v208 offset:208
    ds_read_b128 v[88:91], v208 offset:224
    ds_read_b128 v[92:95], v208 offset:240
    s_lshr_b32 s17, s16, 7
    s_lshl_b32 s17, s17, 7
    s_lshr_b32 s18, s16, 3
    s_and_b32 s18, s18, 15
    s_lshl_b32 s18, s18, 2
    s_add_u32 s17, s17, s18
    s_add_u32 s17, s17, 86016
    s_waitcnt vmcnt(0)
    s_barrier
    s_cmp_lg_u32 s20, 0
    s_cbranch_scc1 S_nofa
    s_mov_b64 exec, 1
    buffer_atomic_swap v226, v227, s[4:7], s17 offen sc1
    s_mov_b64 exec, -1
S_nofa:
    s_setprio 0
    ds_read_b64 v[250:251], v248
    s_waitcnt lgkmcnt(0)
    v_max_i32 v249, v251, v201
    v_add_f32 v250, v250, v202
    v_sub_u32 v251, 0, v249
    v_ldexp_f32 v250, v250, v251
    v_sub_u32 v201, v201, v249
    v_ldexp_f32 v249, v200, v249
    v_mov_b32 v248, v201
    s_lshl_b32 s17, s26, 10
    s_lshl_b32 s18, s20, 8
    s_add_u32 s17, s17, s18
    s_add_u32 s17, s17, 0
    buffer_load_dwordx4 v[160:163], v209, s[4:7], s17 offen offset:0 sc1
    buffer_load_dwordx4 v[164:167], v209, s[4:7], s17 offen offset:16 sc1
    buffer_load_dwordx4 v[168:171], v209, s[4:7], s17 offen offset:32 sc1
    buffer_load_dwordx4 v[172:175], v209, s[4:7], s17 offen offset:48 sc1
    v_pk_mul_f32 v[144:145], v[32:33], v[204:205] op_sel_hi:[1,0]
    v_pk_mul_f32 v[146:147], v[36:37], v[204:205] op_sel_hi:[1,0]
    v_pk_mul_f32 v[148:149], v[40:41], v[204:205] op_sel_hi:[1,0]
    v_pk_mul_f32 v[150:151], v[44:45], v[204:205] op_sel_hi:[1,0]
    v_exp_f32 v144, v144
    v_exp_f32 v146, v146
    v_exp_f32 v148, v148
    v_exp_f32 v150, v150
    v_fract_f32 v145, v145
    v_fract_f32 v147, v147
    v_fract_f32 v149, v149
    v_fract_f32 v151, v151
    v_cos_f32 v112, v145
    v_cos_f32 v114, v147
    v_cos_f32 v116, v149
    v_cos_f32 v118, v151
    v_sin_f32 v113, v145
    v_sin_f32 v115, v147
    v_sin_f32 v117, v149
    v_sin_f32 v119, v151
    v_pk_mul_f32 v[112:113], v[112:113], v[144:145] op_sel_hi:[1,0]
    v_pk_mul_f32 v[114:115], v[114:115], v[146:147] op_sel_hi:[1,0]
    v_pk_mul_f32 v[116:117], v[116:117], v[148:149] op_sel_hi:[1,0]
    v_pk_mul_f32 v[118:119], v[118:119], v[150:151] op_sel_hi:[1,0]
    v_cvt_pk_f16_f32 v120, v112, v113
    v_cvt_pk_f16_f32 v121, v114, v115
    v_cvt_pk_f16_f32 v122, v116, v117
    v_cvt_pk_f16_f32 v123, v118, v119
    v_pk_mul_f32 v[144:145], v[112:113], v[112:113] op_sel_hi:[1,0]
    v_pk_mul_f32 v[146:147], v[114:115], v[114:115] op_sel_hi:[1,0]
    v_pk_mul_f32 v[148:149], v[116:117], v[116:117] op_sel_hi:[1,0]
    v_pk_mul_f32 v[150:151], v[118:119], v[118:119] op_sel_hi:[1,0]
    v_pk_fma_f32 v[112:113], v[112:113], v[112:113], v[144:145] op_sel:[1,1,0] op_sel_hi:[0,1,1] neg_lo:[1,0,0]
    v_pk_fma_f32 v[114:115], v[114:115], v[114:115], v[146:147] op_sel:[1,1,0] op_sel_hi:[0,1,1] neg_lo:[1,0,0]
    v_pk_fma_f32 v[116:117], v[116:117], v[116:117], v[148:149] op_sel:[1,1,0] op_sel_hi:[0,1,1] neg_lo:[1,0,0]
    v_pk_fma_f32 v[118:119], v[118:119], v[118:119], v[150:151] op_sel:[1,1,0] op_sel_hi:[0,1,1] neg_lo:[1,0,0]
    v_cvt_pk_f16_f32 v124, v112, v113
    v_cvt_pk_f16_f32 v125, v114, v115
    v_cvt_pk_f16_f32 v126, v116, v117
    v_cvt_pk_f16_f32 v127, v118, v119
    v_pk_mul_f32 v[144:145], v[112:113], v[112:113] op_sel_hi:[1,0]
    v_pk_mul_f32 v[146:147], v[114:115], v[114:115] op_sel_hi:[1,0]
    v_pk_mul_f32 v[148:149], v[116:117], v[116:117] op_sel_hi:[1,0]
    v_pk_mul_f32 v[150:151], v[118:119], v[118:119] op_sel_hi:[1,0]
    v_pk_fma_f32 v[112:113], v[112:113], v[112:113], v[144:145] op_sel:[1,1,0] op_sel_hi:[0,1,1] neg_lo:[1,0,0]
    v_pk_fma_f32 v[114:115], v[114:115], v[114:115], v[146:147] op_sel:[1,1,0] op_sel_hi:[0,1,1] neg_lo:[1,0,0]
    v_pk_fma_f32 v[116:117], v[116:117], v[116:117], v[148:149] op_sel:[1,1,0] op_sel_hi:[0,1,1] neg_lo:[1,0,0]
    v_pk_fma_f32 v[118:119], v[118:119], v[118:119], v[150:151] op_sel:[1,1,0] op_sel_hi:[0,1,1] neg_lo:[1,0,0]
    v_cvt_pk_f16_f32 v128, v112, v113
    v_cvt_pk_f16_f32 v129, v114, v115
    v_cvt_pk_f16_f32 v130, v116, v117
    v_cvt_pk_f16_f32 v131, v118, v119
    v_pk_mul_f32 v[144:145], v[112:113], v[112:113] op_sel_hi:[1,0]
    v_pk_mul_f32 v[146:147], v[114:115], v[114:115] op_sel_hi:[1,0]
    v_pk_mul_f32 v[148:149], v[116:117], v[116:117] op_sel_hi:[1,0]
    v_pk_mul_f32 v[150:151], v[118:119], v[118:119] op_sel_hi:[1,0]
    v_pk_fma_f32 v[112:113], v[112:113], v[112:113], v[144:145] op_sel:[1,1,0] op_sel_hi:[0,1,1] neg_lo:[1,0,0]
    v_pk_fma_f32 v[114:115], v[114:115], v[114:115], v[146:147] op_sel:[1,1,0] op_sel_hi:[0,1,1] neg_lo:[1,0,0]
    v_pk_fma_f32 v[116:117], v[116:117], v[116:117], v[148:149] op_sel:[1,1,0] op_sel_hi:[0,1,1] neg_lo:[1,0,0]
    v_pk_fma_f32 v[118:119], v[118:119], v[118:119], v[150:151] op_sel:[1,1,0] op_sel_hi:[0,1,1] neg_lo:[1,0,0]
    v_cvt_pk_f16_f32 v132, v112, v113
    v_cvt_pk_f16_f32 v133, v114, v115
    v_cvt_pk_f16_f32 v134, v116, v117
    v_cvt_pk_f16_f32 v135, v118, v119
    v_pk_mul_f32 v[144:145], v[112:113], v[112:113] op_sel_hi:[1,0]
    v_pk_mul_f32 v[146:147], v[114:115], v[114:115] op_sel_hi:[1,0]
    v_pk_mul_f32 v[148:149], v[116:117], v[116:117] op_sel_hi:[1,0]
    v_pk_mul_f32 v[150:151], v[118:119], v[118:119] op_sel_hi:[1,0]
    v_pk_fma_f32 v[112:113], v[112:113], v[112:113], v[144:145] op_sel:[1,1,0] op_sel_hi:[0,1,1] neg_lo:[1,0,0]
    v_pk_fma_f32 v[114:115], v[114:115], v[114:115], v[146:147] op_sel:[1,1,0] op_sel_hi:[0,1,1] neg_lo:[1,0,0]
    v_pk_fma_f32 v[116:117], v[116:117], v[116:117], v[148:149] op_sel:[1,1,0] op_sel_hi:[0,1,1] neg_lo:[1,0,0]
    v_pk_fma_f32 v[118:119], v[118:119], v[118:119], v[150:151] op_sel:[1,1,0] op_sel_hi:[0,1,1] neg_lo:[1,0,0]
    s_mov_b32 exec_lo, 0x80008000
    s_mov_b32 exec_hi, 0x80008000
    v_mov_b64 v[112:113], v[228:229]
    v_mov_b64 v[114:115], v[228:229]
    v_mov_b64 v[116:117], v[228:229]
    v_mov_b64 v[118:119], v[228:229]
    s_mov_b64 exec, -1
    v_pk_mul_f32 v[144:145], v[112:113], v[34:35] op_sel_hi:[1,0] neg_hi:[1,0]
    v_pk_mul_f32 v[146:147], v[114:115], v[38:39] op_sel_hi:[1,0] neg_hi:[1,0]
    v_pk_mul_f32 v[148:149], v[116:117], v[42:43] op_sel_hi:[1,0] neg_hi:[1,0]
    v_pk_mul_f32 v[150:151], v[118:119], v[46:47] op_sel_hi:[1,0] neg_hi:[1,0]
    v_pk_fma_f32 v[144:145], v[112:113], v[34:35], v[144:145] op_sel:[1,1,0] op_sel_hi:[0,1,1] neg_lo:[1,0,0] neg_hi:[1,0,0]
    v_pk_fma_f32 v[146:147], v[114:115], v[38:39], v[146:147] op_sel:[1,1,0] op_sel_hi:[0,1,1] neg_lo:[1,0,0] neg_hi:[1,0,0]
    v_pk_fma_f32 v[148:149], v[116:117], v[42:43], v[148:149] op_sel:[1,1,0] op_sel_hi:[0,1,1] neg_lo:[1,0,0] neg_hi:[1,0,0]
    v_pk_fma_f32 v[150:151], v[118:119], v[46:47], v[150:151] op_sel:[1,1,0] op_sel_hi:[0,1,1] neg_lo:[1,0,0] neg_hi:[1,0,0]
    v_cvt_pk_f16_f32 v136, v144, v145
    v_cvt_pk_f16_f32 v137, v146, v147
    v_cvt_pk_f16_f32 v138, v148, v149
    v_cvt_pk_f16_f32 v139, v150, v151
    v_pk_mul_f32 v[144:145], v[112:113], v[112:113] op_sel_hi:[1,0]
    v_pk_mul_f32 v[146:147], v[114:115], v[114:115] op_sel_hi:[1,0]
    v_pk_mul_f32 v[148:149], v[116:117], v[116:117] op_sel_hi:[1,0]
    v_pk_mul_f32 v[150:151], v[118:119], v[118:119] op_sel_hi:[1,0]
    v_pk_fma_f32 v[112:113], v[112:113], v[112:113], v[144:145] op_sel:[1,1,0] op_sel_hi:[0,1,1] neg_lo:[1,0,0]
    v_pk_fma_f32 v[114:115], v[114:115], v[114:115], v[146:147] op_sel:[1,1,0] op_sel_hi:[0,1,1] neg_lo:[1,0,0]
    v_pk_fma_f32 v[116:117], v[116:117], v[116:117], v[148:149] op_sel:[1,1,0] op_sel_hi:[0,1,1] neg_lo:[1,0,0]
    v_pk_fma_f32 v[118:119], v[118:119], v[118:119], v[150:151] op_sel:[1,1,0] op_sel_hi:[0,1,1] neg_lo:[1,0,0]
    v_mfma_f32_16x16x32_f16 v[96:99], v[120:123], v[136:139], 0
    v_pk_mul_f32 v[144:145], v[112:113], v[34:35] op_sel_hi:[1,0] neg_hi:[1,0]
    v_pk_mul_f32 v[146:147], v[114:115], v[38:39] op_sel_hi:[1,0] neg_hi:[1,0]
    v_pk_mul_f32 v[148:149], v[116:117], v[42:43] op_sel_hi:[1,0] neg_hi:[1,0]
    v_pk_mul_f32 v[150:151], v[118:119], v[46:47] op_sel_hi:[1,0] neg_hi:[1,0]
    v_pk_fma_f32 v[144:145], v[112:113], v[34:35], v[144:145] op_sel:[1,1,0] op_sel_hi:[0,1,1] neg_lo:[1,0,0] neg_hi:[1,0,0]
    v_pk_fma_f32 v[146:147], v[114:115], v[38:39], v[146:147] op_sel:[1,1,0] op_sel_hi:[0,1,1] neg_lo:[1,0,0] neg_hi:[1,0,0]
    v_pk_fma_f32 v[148:149], v[116:117], v[42:43], v[148:149] op_sel:[1,1,0] op_sel_hi:[0,1,1] neg_lo:[1,0,0] neg_hi:[1,0,0]
    v_pk_fma_f32 v[150:151], v[118:119], v[46:47], v[150:151] op_sel:[1,1,0] op_sel_hi:[0,1,1] neg_lo:[1,0,0] neg_hi:[1,0,0]
    v_cvt_pk_f16_f32 v140, v144, v145
    v_cvt_pk_f16_f32 v141, v146, v147
    v_cvt_pk_f16_f32 v142, v148, v149
    v_cvt_pk_f16_f32 v143, v150, v151
    v_pk_mul_f32 v[144:145], v[112:113], v[112:113] op_sel_hi:[1,0]
    v_pk_mul_f32 v[146:147], v[114:115], v[114:115] op_sel_hi:[1,0]
    v_pk_mul_f32 v[148:149], v[116:117], v[116:117] op_sel_hi:[1,0]
    v_pk_mul_f32 v[150:151], v[118:119], v[118:119] op_sel_hi:[1,0]
    v_pk_fma_f32 v[112:113], v[112:113], v[112:113], v[144:145] op_sel:[1,1,0] op_sel_hi:[0,1,1] neg_lo:[1,0,0]
    v_pk_fma_f32 v[114:115], v[114:115], v[114:115], v[146:147] op_sel:[1,1,0] op_sel_hi:[0,1,1] neg_lo:[1,0,0]
    v_pk_fma_f32 v[116:117], v[116:117], v[116:117], v[148:149] op_sel:[1,1,0] op_sel_hi:[0,1,1] neg_lo:[1,0,0]
    v_pk_fma_f32 v[118:119], v[118:119], v[118:119], v[150:151] op_sel:[1,1,0] op_sel_hi:[0,1,1] neg_lo:[1,0,0]
    v_mfma_f32_16x16x32_f16 v[100:103], v[124:127], v[140:143], 0
    v_pk_mul_f32 v[144:145], v[112:113], v[34:35] op_sel_hi:[1,0] neg_hi:[1,0]
    v_pk_mul_f32 v[146:147], v[114:115], v[38:39] op_sel_hi:[1,0] neg_hi:[1,0]
    v_pk_mul_f32 v[148:149], v[116:117], v[42:43] op_sel_hi:[1,0] neg_hi:[1,0]
    v_pk_mul_f32 v[150:151], v[118:119], v[46:47] op_sel_hi:[1,0] neg_hi:[1,0]
    v_pk_fma_f32 v[144:145], v[112:113], v[34:35], v[144:145] op_sel:[1,1,0] op_sel_hi:[0,1,1] neg_lo:[1,0,0] neg_hi:[1,0,0]
    v_pk_fma_f32 v[146:147], v[114:115], v[38:39], v[146:147] op_sel:[1,1,0] op_sel_hi:[0,1,1] neg_lo:[1,0,0] neg_hi:[1,0,0]
    v_pk_fma_f32 v[148:149], v[116:117], v[42:43], v[148:149] op_sel:[1,1,0] op_sel_hi:[0,1,1] neg_lo:[1,0,0] neg_hi:[1,0,0]
    v_pk_fma_f32 v[150:151], v[118:119], v[46:47], v[150:151] op_sel:[1,1,0] op_sel_hi:[0,1,1] neg_lo:[1,0,0] neg_hi:[1,0,0]
    v_cvt_pk_f16_f32 v136, v144, v145
    v_cvt_pk_f16_f32 v137, v146, v147
    v_cvt_pk_f16_f32 v138, v148, v149
    v_cvt_pk_f16_f32 v139, v150, v151
    v_pk_mul_f32 v[144:145], v[112:113], v[112:113] op_sel_hi:[1,0]
    v_pk_mul_f32 v[146:147], v[114:115], v[114:115] op_sel_hi:[1,0]
    v_pk_mul_f32 v[148:149], v[116:117], v[116:117] op_sel_hi:[1,0]
    v_pk_mul_f32 v[150:151], v[118:119], v[118:119] op_sel_hi:[1,0]
    v_pk_fma_f32 v[112:113], v[112:113], v[112:113], v[144:145] op_sel:[1,1,0] op_sel_hi:[0,1,1] neg_lo:[1,0,0]
    v_pk_fma_f32 v[114:115], v[114:115], v[114:115], v[146:147] op_sel:[1,1,0] op_sel_hi:[0,1,1] neg_lo:[1,0,0]
    v_pk_fma_f32 v[116:117], v[116:117], v[116:117], v[148:149] op_sel:[1,1,0] op_sel_hi:[0,1,1] neg_lo:[1,0,0]
    v_pk_fma_f32 v[118:119], v[118:119], v[118:119], v[150:151] op_sel:[1,1,0] op_sel_hi:[0,1,1] neg_lo:[1,0,0]
    v_mfma_f32_16x16x32_f16 v[104:107], v[128:131], v[136:139], 0
    v_pk_mul_f32 v[144:145], v[112:113], v[34:35] op_sel_hi:[1,0] neg_hi:[1,0]
    v_pk_mul_f32 v[146:147], v[114:115], v[38:39] op_sel_hi:[1,0] neg_hi:[1,0]
    v_pk_mul_f32 v[148:149], v[116:117], v[42:43] op_sel_hi:[1,0] neg_hi:[1,0]
    v_pk_mul_f32 v[150:151], v[118:119], v[46:47] op_sel_hi:[1,0] neg_hi:[1,0]
    v_pk_fma_f32 v[144:145], v[112:113], v[34:35], v[144:145] op_sel:[1,1,0] op_sel_hi:[0,1,1] neg_lo:[1,0,0] neg_hi:[1,0,0]
    v_pk_fma_f32 v[146:147], v[114:115], v[38:39], v[146:147] op_sel:[1,1,0] op_sel_hi:[0,1,1] neg_lo:[1,0,0] neg_hi:[1,0,0]
    v_pk_fma_f32 v[148:149], v[116:117], v[42:43], v[148:149] op_sel:[1,1,0] op_sel_hi:[0,1,1] neg_lo:[1,0,0] neg_hi:[1,0,0]
    v_pk_fma_f32 v[150:151], v[118:119], v[46:47], v[150:151] op_sel:[1,1,0] op_sel_hi:[0,1,1] neg_lo:[1,0,0] neg_hi:[1,0,0]
    v_cvt_pk_f16_f32 v140, v144, v145
    v_cvt_pk_f16_f32 v141, v146, v147
    v_cvt_pk_f16_f32 v142, v148, v149
    v_cvt_pk_f16_f32 v143, v150, v151
    s_nop 1
    v_mfma_f32_16x16x32_f16 v[108:111], v[132:135], v[140:143], 0
    s_setprio 0
    s_waitcnt vmcnt(0)
    ds_read_b64_tr_b16 v[176:177], v210 offset:0
    ds_read_b64_tr_b16 v[178:179], v210 offset:256
    ds_read_b64_tr_b16 v[180:181], v210 offset:32
    ds_read_b64_tr_b16 v[182:183], v210 offset:288
    v_xor_b32 v255, v161, v226
    v_xor_b32 v254, v163, v226
    v_or_b32 v255, v255, v254
    v_xor_b32 v254, v165, v226
    v_or_b32 v255, v255, v254
    v_xor_b32 v254, v167, v226
    v_or_b32 v255, v255, v254
    v_xor_b32 v254, v169, v226
    v_or_b32 v255, v255, v254
    v_xor_b32 v254, v171, v226
    v_or_b32 v255, v255, v254
    v_xor_b32 v254, v173, v226
    v_or_b32 v255, v255, v254
    v_xor_b32 v254, v175, v226
    v_or_b32 v255, v255, v254
    v_cmp_ne_u32 vcc, 0, v255
    s_nop 3
    s_cbranch_vccz S_st_ok
    s_mov_b32 s12, 0
    s_sleep 6
S_st_poll:
    buffer_load_dwordx4 v[160:163], v209, s[4:7], s17 offen offset:0 sc1
    buffer_load_dwordx4 v[164:167], v209, s[4:7], s17 offen offset:16 sc1
    buffer_load_dwordx4 v[168:171], v209, s[4:7], s17 offen offset:32 sc1
    buffer_load_dwordx4 v[172:175], v209, s[4:7], s17 offen offset:48 sc1
    s_add_u32 s12, s12, 1
    s_waitcnt vmcnt(0)
    v_xor_b32 v255, v161, v226
    v_xor_b32 v254, v163, v226
    v_or_b32 v255, v255, v254
    v_xor_b32 v254, v165, v226
    v_or_b32 v255, v255, v254
    v_xor_b32 v254, v167, v226
    v_or_b32 v255, v255, v254
    v_xor_b32 v254, v169, v226
    v_or_b32 v255, v255, v254
    v_xor_b32 v254, v171, v226
    v_or_b32 v255, v255, v254
    v_xor_b32 v254, v173, v226
    v_or_b32 v255, v255, v254
    v_xor_b32 v254, v175, v226
    v_or_b32 v255, v255, v254
    v_cmp_ne_u32 vcc, 0, v255
    s_nop 3
    s_cbranch_vccz S_st_ok
    s_cmp_gt_u32 s12, 200000
    s_cbranch_scc1 S_st_ok
    s_sleep 6
    s_branch S_st_poll
S_st_ok:
    v_and_b32 v184, s19, v160
    v_lshlrev_b32 v185, 16, v160
    v_and_b32 v186, s19, v162
    v_lshlrev_b32 v187, 16, v162
    v_and_b32 v188, s19, v164
    v_lshlrev_b32 v189, 16, v164
    v_and_b32 v190, s19, v166
    v_lshlrev_b32 v191, 16, v166
    v_and_b32 v192, s19, v168
    v_lshlrev_b32 v193, 16, v168
    v_and_b32 v194, s19, v170
    v_lshlrev_b32 v195, 16, v170
    v_and_b32 v196, s19, v172
    v_lshlrev_b32 v197, 16, v172
    v_and_b32 v198, s19, v174
    v_lshlrev_b32 v199, 16, v174
    v_rcp_f32 v185, v185
    v_rcp_f32 v187, v187
    v_rcp_f32 v189, v189
    v_rcp_f32 v191, v191
    v_rcp_f32 v193, v193
    v_rcp_f32 v195, v195
    v_rcp_f32 v197, v197
    v_rcp_f32 v199, v199
    s_mul_i32 s17, s27, 135168
    s_lshl_b32 s18, s26, 8
    s_add_u32 s17, s17, s18
    s_lshl_b32 s18, s20, 6
    s_add_u32 s17, s17, s18
    s_add_u32 s17, s17, 2097216
    s_add_u32 s18, s17, 67584
    s_waitcnt lgkmcnt(0)
    v_lshlrev_b32 v16, 16, v176
    v_lshlrev_b32 v17, 16, v180
    v_and_b32 v18, s19, v176
    v_and_b32 v19, s19, v180
    v_lshlrev_b32 v20, 16, v177
    v_lshlrev_b32 v21, 16, v181
    v_and_b32 v22, s19, v177
    v_and_b32 v23, s19, v181
    v_lshlrev_b32 v24, 16, v178
    v_lshlrev_b32 v25, 16, v182
    v_and_b32 v26, s19, v178
    v_and_b32 v27, s19, v182
    v_lshlrev_b32 v28, 16, v179
    v_lshlrev_b32 v29, 16, v183
    v_and_b32 v30, s19, v179
    v_and_b32 v31, s19, v183
    v_pk_add_f32 v[16:17], v[16:17], v[184:185] op_sel_hi:[1,0] neg_lo:[0,1] neg_hi:[0,1]
    v_pk_add_f32 v[18:19], v[18:19], v[186:187] op_sel_hi:[1,0] neg_lo:[0,1] neg_hi:[0,1]
    v_pk_add_f32 v[20:21], v[20:21], v[188:189] op_sel_hi:[1,0] neg_lo:[0,1] neg_hi:[0,1]
    v_pk_add_f32 v[22:23], v[22:23], v[190:191] op_sel_hi:[1,0] neg_lo:[0,1] neg_hi:[0,1]
    v_pk_add_f32 v[24:25], v[24:25], v[192:193] op_sel_hi:[1,0] neg_lo:[0,1] neg_hi:[0,1]
    v_pk_add_f32 v[26:27], v[26:27], v[194:195] op_sel_hi:[1,0] neg_lo:[0,1] neg_hi:[0,1]
    v_pk_add_f32 v[28:29], v[28:29], v[196:197] op_sel_hi:[1,0] neg_lo:[0,1] neg_hi:[0,1]
    v_pk_add_f32 v[30:31], v[30:31], v[198:199] op_sel_hi:[1,0] neg_lo:[0,1] neg_hi:[0,1]
    v_cvt_pk_bf16_f32 v160, v16, v17
    v_cvt_pk_bf16_f32 v161, v18, v19
    v_cvt_pk_bf16_f32 v162, v20, v21
    v_cvt_pk_bf16_f32 v163, v22, v23
    v_cvt_pk_bf16_f32 v164, v24, v25
    v_cvt_pk_bf16_f32 v165, v26, v27
    v_cvt_pk_bf16_f32 v166, v28, v29
    v_cvt_pk_bf16_f32 v167, v30, v31
    v_lshlrev_b32 v16, 16, v160
    v_and_b32 v17, s19, v160
    v_lshlrev_b32 v18, 16, v161
    v_and_b32 v19, s19, v161
    v_lshlrev_b32 v20, 16, v162
    v_and_b32 v21, s19, v162
    v_lshlrev_b32 v22, 16, v163
    v_and_b32 v23, s19, v163
    v_lshlrev_b32 v24, 16, v164
    v_and_b32 v25, s19, v164
    v_lshlrev_b32 v26, 16, v165
    v_and_b32 v27, s19, v165
    v_lshlrev_b32 v28, 16, v166
    v_and_b32 v29, s19, v166
    v_lshlrev_b32 v30, 16, v167
    v_and_b32 v31, s19, v167
    v_pk_mul_f32 v[16:17], v[16:17], v[184:185] op_sel:[0,1] op_sel_hi:[1,1]
    v_pk_mul_f32 v[18:19], v[18:19], v[186:187] op_sel:[0,1] op_sel_hi:[1,1]
    v_pk_mul_f32 v[20:21], v[20:21], v[188:189] op_sel:[0,1] op_sel_hi:[1,1]
    v_pk_mul_f32 v[22:23], v[22:23], v[190:191] op_sel:[0,1] op_sel_hi:[1,1]
    v_pk_mul_f32 v[24:25], v[24:25], v[192:193] op_sel:[0,1] op_sel_hi:[1,1]
    v_pk_mul_f32 v[26:27], v[26:27], v[194:195] op_sel:[0,1] op_sel_hi:[1,1]
    v_pk_mul_f32 v[28:29], v[28:29], v[196:197] op_sel:[0,1] op_sel_hi:[1,1]
    v_pk_mul_f32 v[30:31], v[30:31], v[198:199] op_sel:[0,1] op_sel_hi:[1,1]
    v_cvt_pk_bf16_f32 v176, v16, v18
    v_cvt_pk_bf16_f32 v177, v20, v22
    v_cvt_pk_bf16_f32 v178, v24, v26
    v_cvt_pk_bf16_f32 v179, v28, v30
    v_cvt_pk_bf16_f32 v180, v17, v19
    v_cvt_pk_bf16_f32 v181, v21, v23
    v_cvt_pk_bf16_f32 v182, v25, v27
    v_cvt_pk_bf16_f32 v183, v29, v31
    v_lshlrev_b32 v16, 16, v176
    v_and_b32 v17, s19, v176
    v_lshlrev_b32 v18, 16, v177
    v_and_b32 v19, s19, v177
    v_lshlrev_b32 v20, 16, v178
    v_and_b32 v21, s19, v178
    v_lshlrev_b32 v22, 16, v179
    v_and_b32 v23, s19, v179
    v_lshlrev_b32 v24, 16, v180
    v_and_b32 v25, s19, v180
    v_lshlrev_b32 v26, 16, v181
    v_and_b32 v27, s19, v181
    v_lshlrev_b32 v28, 16, v182
    v_and_b32 v29, s19, v182
    v_lshlrev_b32 v30, 16, v183
    v_and_b32 v31, s19, v183
    v_cvt_pk_f16_f32 v176, v16, v17
    v_cvt_pk_f16_f32 v177, v18, v19
    v_cvt_pk_f16_f32 v178, v20, v21
    v_cvt_pk_f16_f32 v179, v22, v23
    v_cvt_pk_f16_f32 v180, v24, v25
    v_cvt_pk_f16_f32 v181, v26, v27
    v_cvt_pk_f16_f32 v182, v28, v29
    v_cvt_pk_f16_f32 v183, v30, v31
    buffer_store_dwordx4 v[176:179], v211, s[4:7], s17 offen sc1
    buffer_store_dwordx4 v[180:183], v211, s[4:7], s18 offen sc1
    s_cmp_lg_u32 s26, 0
    s_cbranch_scc1 S_nopad
    s_cmp_gt_u32 s20, 1
    s_cbranch_scc1 S_nopad
    v_lshrrev_b32 v19, 2, v2
    v_mul_u32_u24 v19, 4224, v19
    v_and_b32 v18, 3, v2
    v_lshl_add_u32 v19, v18, 4, v19
    s_lshl_b32 s17, s27, 1
    s_add_u32 s17, s17, s20
    s_mul_i32 s17, s17, 67584
    s_add_u32 s17, s17, 2097152
    v_mov_b32 v20, 0
    v_mov_b32 v21, 0
    v_mov_b32 v22, 0
    v_mov_b32 v23, 0
    buffer_store_dwordx4 v[20:23], v19, s[4:7], s17 offen sc1
S_nopad:
    s_setprio 0
    v_pk_mul_f32 v[144:145], v[48:49], v[204:205] op_sel_hi:[1,0]
    v_pk_mul_f32 v[146:147], v[52:53], v[204:205] op_sel_hi:[1,0]
    v_pk_mul_f32 v[148:149], v[56:57], v[204:205] op_sel_hi:[1,0]
    v_pk_mul_f32 v[150:151], v[60:61], v[204:205] op_sel_hi:[1,0]
    v_exp_f32 v144, v144
    v_exp_f32 v146, v146
    v_exp_f32 v148, v148
    v_exp_f32 v150, v150
    v_fract_f32 v145, v145
    v_fract_f32 v147, v147
    v_fract_f32 v149, v149
    v_fract_f32 v151, v151
    v_cos_f32 v112, v145
    v_cos_f32 v114, v147
    v_cos_f32 v116, v149
    v_cos_f32 v118, v151
    v_sin_f32 v113, v145
    v_sin_f32 v115, v147
    v_sin_f32 v117, v149
    v_sin_f32 v119, v151
    v_pk_mul_f32 v[112:113], v[112:113], v[144:145] op_sel_hi:[1,0]
    v_pk_mul_f32 v[114:115], v[114:115], v[146:147] op_sel_hi:[1,0]
    v_pk_mul_f32 v[116:117], v[116:117], v[148:149] op_sel_hi:[1,0]
    v_pk_mul_f32 v[118:119], v[118:119], v[150:151] op_sel_hi:[1,0]
    v_cvt_pk_f16_f32 v120, v112, v113
    v_cvt_pk_f16_f32 v121, v114, v115
    v_cvt_pk_f16_f32 v122, v116, v117
    v_cvt_pk_f16_f32 v123, v118, v119
    v_pk_mul_f32 v[144:145], v[112:113], v[112:113] op_sel_hi:[1,0]
    v_pk_mul_f32 v[146:147], v[114:115], v[114:115] op_sel_hi:[1,0]
    v_pk_mul_f32 v[148:149], v[116:117], v[116:117] op_sel_hi:[1,0]
    v_pk_mul_f32 v[150:151], v[118:119], v[118:119] op_sel_hi:[1,0]
    v_pk_fma_f32 v[112:113], v[112:113], v[112:113], v[144:145] op_sel:[1,1,0] op_sel_hi:[0,1,1] neg_lo:[1,0,0]
    v_pk_fma_f32 v[114:115], v[114:115], v[114:115], v[146:147] op_sel:[1,1,0] op_sel_hi:[0,1,1] neg_lo:[1,0,0]
    v_pk_fma_f32 v[116:117], v[116:117], v[116:117], v[148:149] op_sel:[1,1,0] op_sel_hi:[0,1,1] neg_lo:[1,0,0]
    v_pk_fma_f32 v[118:119], v[118:119], v[118:119], v[150:151] op_sel:[1,1,0] op_sel_hi:[0,1,1] neg_lo:[1,0,0]
    v_cvt_pk_f16_f32 v124, v112, v113
    v_cvt_pk_f16_f32 v125, v114, v115
    v_cvt_pk_f16_f32 v126, v116, v117
    v_cvt_pk_f16_f32 v127, v118, v119
    v_pk_mul_f32 v[144:145], v[112:113], v[112:113] op_sel_hi:[1,0]
    v_pk_mul_f32 v[146:147], v[114:115], v[114:115] op_sel_hi:[1,0]
    v_pk_mul_f32 v[148:149], v[116:117], v[116:117] op_sel_hi:[1,0]
    v_pk_mul_f32 v[150:151], v[118:119], v[118:119] op_sel_hi:[1,0]
    v_pk_fma_f32 v[112:113], v[112:113], v[112:113], v[144:145] op_sel:[1,1,0] op_sel_hi:[0,1,1] neg_lo:[1,0,0]
    v_pk_fma_f32 v[114:115], v[114:115], v[114:115], v[146:147] op_sel:[1,1,0] op_sel_hi:[0,1,1] neg_lo:[1,0,0]
    v_pk_fma_f32 v[116:117], v[116:117], v[116:117], v[148:149] op_sel:[1,1,0] op_sel_hi:[0,1,1] neg_lo:[1,0,0]
    v_pk_fma_f32 v[118:119], v[118:119], v[118:119], v[150:151] op_sel:[1,1,0] op_sel_hi:[0,1,1] neg_lo:[1,0,0]
    v_cvt_pk_f16_f32 v128, v112, v113
    v_cvt_pk_f16_f32 v129, v114, v115
    v_cvt_pk_f16_f32 v130, v116, v117
    v_cvt_pk_f16_f32 v131, v118, v119
    v_pk_mul_f32 v[144:145], v[112:113], v[112:113] op_sel_hi:[1,0]
    v_pk_mul_f32 v[146:147], v[114:115], v[114:115] op_sel_hi:[1,0]
    v_pk_mul_f32 v[148:149], v[116:117], v[116:117] op_sel_hi:[1,0]
    v_pk_mul_f32 v[150:151], v[118:119], v[118:119] op_sel_hi:[1,0]
    v_pk_fma_f32 v[112:113], v[112:113], v[112:113], v[144:145] op_sel:[1,1,0] op_sel_hi:[0,1,1] neg_lo:[1,0,0]
    v_pk_fma_f32 v[114:115], v[114:115], v[114:115], v[146:147] op_sel:[1,1,0] op_sel_hi:[0,1,1] neg_lo:[1,0,0]
    v_pk_fma_f32 v[116:117], v[116:117], v[116:117], v[148:149] op_sel:[1,1,0] op_sel_hi:[0,1,1] neg_lo:[1,0,0]
    v_pk_fma_f32 v[118:119], v[118:119], v[118:119], v[150:151] op_sel:[1,1,0] op_sel_hi:[0,1,1] neg_lo:[1,0,0]
    v_cvt_pk_f16_f32 v132, v112, v113
    v_cvt_pk_f16_f32 v133, v114, v115
    v_cvt_pk_f16_f32 v134, v116, v117
    v_cvt_pk_f16_f32 v135, v118, v119
    v_pk_mul_f32 v[144:145], v[112:113], v[112:113] op_sel_hi:[1,0]
    v_pk_mul_f32 v[146:147], v[114:115], v[114:115] op_sel_hi:[1,0]
    v_pk_mul_f32 v[148:149], v[116:117], v[116:117] op_sel_hi:[1,0]
    v_pk_mul_f32 v[150:151], v[118:119], v[118:119] op_sel_hi:[1,0]
    v_pk_fma_f32 v[112:113], v[112:113], v[112:113], v[144:145] op_sel:[1,1,0] op_sel_hi:[0,1,1] neg_lo:[1,0,0]
    v_pk_fma_f32 v[114:115], v[114:115], v[114:115], v[146:147] op_sel:[1,1,0] op_sel_hi:[0,1,1] neg_lo:[1,0,0]
    v_pk_fma_f32 v[116:117], v[116:117], v[116:117], v[148:149] op_sel:[1,1,0] op_sel_hi:[0,1,1] neg_lo:[1,0,0]
    v_pk_fma_f32 v[118:119], v[118:119], v[118:119], v[150:151] op_sel:[1,1,0] op_sel_hi:[0,1,1] neg_lo:[1,0,0]
    s_mov_b32 exec_lo, 0x80008000
    s_mov_b32 exec_hi, 0x80008000
    v_mov_b64 v[112:113], v[228:229]
    v_mov_b64 v[114:115], v[228:229]
    v_mov_b64 v[116:117], v[228:229]
    v_mov_b64 v[118:119], v[228:229]
    s_mov_b64 exec, -1
    v_pk_mul_f32 v[144:145], v[112:113], v[50:51] op_sel_hi:[1,0] neg_hi:[1,0]
    v_pk_mul_f32 v[146:147], v[114:115], v[54:55] op_sel_hi:[1,0] neg_hi:[1,0]
    v_pk_mul_f32 v[148:149], v[116:117], v[58:59] op_sel_hi:[1,0] neg_hi:[1,0]
    v_pk_mul_f32 v[150:151], v[118:119], v[62:63] op_sel_hi:[1,0] neg_hi:[1,0]
    v_pk_fma_f32 v[144:145], v[112:113], v[50:51], v[144:145] op_sel:[1,1,0] op_sel_hi:[0,1,1] neg_lo:[1,0,0] neg_hi:[1,0,0]
    v_pk_fma_f32 v[146:147], v[114:115], v[54:55], v[146:147] op_sel:[1,1,0] op_sel_hi:[0,1,1] neg_lo:[1,0,0] neg_hi:[1,0,0]
    v_pk_fma_f32 v[148:149], v[116:117], v[58:59], v[148:149] op_sel:[1,1,0] op_sel_hi:[0,1,1] neg_lo:[1,0,0] neg_hi:[1,0,0]
    v_pk_fma_f32 v[150:151], v[118:119], v[62:63], v[150:151] op_sel:[1,1,0] op_sel_hi:[0,1,1] neg_lo:[1,0,0] neg_hi:[1,0,0]
    v_cvt_pk_f16_f32 v136, v144, v145
    v_cvt_pk_f16_f32 v137, v146, v147
    v_cvt_pk_f16_f32 v138, v148, v149
    v_cvt_pk_f16_f32 v139, v150, v151
    v_pk_mul_f32 v[144:145], v[112:113], v[112:113] op_sel_hi:[1,0]
    v_pk_mul_f32 v[146:147], v[114:115], v[114:115] op_sel_hi:[1,0]
    v_pk_mul_f32 v[148:149], v[116:117], v[116:117] op_sel_hi:[1,0]
    v_pk_mul_f32 v[150:151], v[118:119], v[118:119] op_sel_hi:[1,0]
    v_pk_fma_f32 v[112:113], v[112:113], v[112:113], v[144:145] op_sel:[1,1,0] op_sel_hi:[0,1,1] neg_lo:[1,0,0]
    v_pk_fma_f32 v[114:115], v[114:115], v[114:115], v[146:147] op_sel:[1,1,0] op_sel_hi:[0,1,1] neg_lo:[1,0,0]
    v_pk_fma_f32 v[116:117], v[116:117], v[116:117], v[148:149] op_sel:[1,1,0] op_sel_hi:[0,1,1] neg_lo:[1,0,0]
    v_pk_fma_f32 v[118:119], v[118:119], v[118:119], v[150:151] op_sel:[1,1,0] op_sel_hi:[0,1,1] neg_lo:[1,0,0]
    v_mfma_f32_16x16x32_f16 v[96:99], v[120:123], v[136:139], v[96:99]
    v_pk_mul_f32 v[144:145], v[112:113], v[50:51] op_sel_hi:[1,0] neg_hi:[1,0]
    v_pk_mul_f32 v[146:147], v[114:115], v[54:55] op_sel_hi:[1,0] neg_hi:[1,0]
    v_pk_mul_f32 v[148:149], v[116:117], v[58:59] op_sel_hi:[1,0] neg_hi:[1,0]
    v_pk_mul_f32 v[150:151], v[118:119], v[62:63] op_sel_hi:[1,0] neg_hi:[1,0]
    v_pk_fma_f32 v[144:145], v[112:113], v[50:51], v[144:145] op_sel:[1,1,0] op_sel_hi:[0,1,1] neg_lo:[1,0,0] neg_hi:[1,0,0]
    v_pk_fma_f32 v[146:147], v[114:115], v[54:55], v[146:147] op_sel:[1,1,0] op_sel_hi:[0,1,1] neg_lo:[1,0,0] neg_hi:[1,0,0]
    v_pk_fma_f32 v[148:149], v[116:117], v[58:59], v[148:149] op_sel:[1,1,0] op_sel_hi:[0,1,1] neg_lo:[1,0,0] neg_hi:[1,0,0]
    v_pk_fma_f32 v[150:151], v[118:119], v[62:63], v[150:151] op_sel:[1,1,0] op_sel_hi:[0,1,1] neg_lo:[1,0,0] neg_hi:[1,0,0]
    v_cvt_pk_f16_f32 v140, v144, v145
    v_cvt_pk_f16_f32 v141, v146, v147
    v_cvt_pk_f16_f32 v142, v148, v149
    v_cvt_pk_f16_f32 v143, v150, v151
    v_pk_mul_f32 v[144:145], v[112:113], v[112:113] op_sel_hi:[1,0]
    v_pk_mul_f32 v[146:147], v[114:115], v[114:115] op_sel_hi:[1,0]
    v_pk_mul_f32 v[148:149], v[116:117], v[116:117] op_sel_hi:[1,0]
    v_pk_mul_f32 v[150:151], v[118:119], v[118:119] op_sel_hi:[1,0]
    v_pk_fma_f32 v[112:113], v[112:113], v[112:113], v[144:145] op_sel:[1,1,0] op_sel_hi:[0,1,1] neg_lo:[1,0,0]
    v_pk_fma_f32 v[114:115], v[114:115], v[114:115], v[146:147] op_sel:[1,1,0] op_sel_hi:[0,1,1] neg_lo:[1,0,0]
    v_pk_fma_f32 v[116:117], v[116:117], v[116:117], v[148:149] op_sel:[1,1,0] op_sel_hi:[0,1,1] neg_lo:[1,0,0]
    v_pk_fma_f32 v[118:119], v[118:119], v[118:119], v[150:151] op_sel:[1,1,0] op_sel_hi:[0,1,1] neg_lo:[1,0,0]
    v_mfma_f32_16x16x32_f16 v[100:103], v[124:127], v[140:143], v[100:103]
    v_pk_mul_f32 v[144:145], v[112:113], v[50:51] op_sel_hi:[1,0] neg_hi:[1,0]
    v_pk_mul_f32 v[146:147], v[114:115], v[54:55] op_sel_hi:[1,0] neg_hi:[1,0]
    v_pk_mul_f32 v[148:149], v[116:117], v[58:59] op_sel_hi:[1,0] neg_hi:[1,0]
    v_pk_mul_f32 v[150:151], v[118:119], v[62:63] op_sel_hi:[1,0] neg_hi:[1,0]
    v_pk_fma_f32 v[144:145], v[112:113], v[50:51], v[144:145] op_sel:[1,1,0] op_sel_hi:[0,1,1] neg_lo:[1,0,0] neg_hi:[1,0,0]
    v_pk_fma_f32 v[146:147], v[114:115], v[54:55], v[146:147] op_sel:[1,1,0] op_sel_hi:[0,1,1] neg_lo:[1,0,0] neg_hi:[1,0,0]
    v_pk_fma_f32 v[148:149], v[116:117], v[58:59], v[148:149] op_sel:[1,1,0] op_sel_hi:[0,1,1] neg_lo:[1,0,0] neg_hi:[1,0,0]
    v_pk_fma_f32 v[150:151], v[118:119], v[62:63], v[150:151] op_sel:[1,1,0] op_sel_hi:[0,1,1] neg_lo:[1,0,0] neg_hi:[1,0,0]
    v_cvt_pk_f16_f32 v136, v144, v145
    v_cvt_pk_f16_f32 v137, v146, v147
    v_cvt_pk_f16_f32 v138, v148, v149
    v_cvt_pk_f16_f32 v139, v150, v151
    v_pk_mul_f32 v[144:145], v[112:113], v[112:113] op_sel_hi:[1,0]
    v_pk_mul_f32 v[146:147], v[114:115], v[114:115] op_sel_hi:[1,0]
    v_pk_mul_f32 v[148:149], v[116:117], v[116:117] op_sel_hi:[1,0]
    v_pk_mul_f32 v[150:151], v[118:119], v[118:119] op_sel_hi:[1,0]
    v_pk_fma_f32 v[112:113], v[112:113], v[112:113], v[144:145] op_sel:[1,1,0] op_sel_hi:[0,1,1] neg_lo:[1,0,0]
    v_pk_fma_f32 v[114:115], v[114:115], v[114:115], v[146:147] op_sel:[1,1,0] op_sel_hi:[0,1,1] neg_lo:[1,0,0]
    v_pk_fma_f32 v[116:117], v[116:117], v[116:117], v[148:149] op_sel:[1,1,0] op_sel_hi:[0,1,1] neg_lo:[1,0,0]
    v_pk_fma_f32 v[118:119], v[118:119], v[118:119], v[150:151] op_sel:[1,1,0] op_sel_hi:[0,1,1] neg_lo:[1,0,0]
    v_mfma_f32_16x16x32_f16 v[104:107], v[128:131], v[136:139], v[104:107]
    v_pk_mul_f32 v[144:145], v[112:113], v[50:51] op_sel_hi:[1,0] neg_hi:[1,0]
    v_pk_mul_f32 v[146:147], v[114:115], v[54:55] op_sel_hi:[1,0] neg_hi:[1,0]
    v_pk_mul_f32 v[148:149], v[116:117], v[58:59] op_sel_hi:[1,0] neg_hi:[1,0]
    v_pk_mul_f32 v[150:151], v[118:119], v[62:63] op_sel_hi:[1,0] neg_hi:[1,0]
    v_pk_fma_f32 v[144:145], v[112:113], v[50:51], v[144:145] op_sel:[1,1,0] op_sel_hi:[0,1,1] neg_lo:[1,0,0] neg_hi:[1,0,0]
    v_pk_fma_f32 v[146:147], v[114:115], v[54:55], v[146:147] op_sel:[1,1,0] op_sel_hi:[0,1,1] neg_lo:[1,0,0] neg_hi:[1,0,0]
    v_pk_fma_f32 v[148:149], v[116:117], v[58:59], v[148:149] op_sel:[1,1,0] op_sel_hi:[0,1,1] neg_lo:[1,0,0] neg_hi:[1,0,0]
    v_pk_fma_f32 v[150:151], v[118:119], v[62:63], v[150:151] op_sel:[1,1,0] op_sel_hi:[0,1,1] neg_lo:[1,0,0] neg_hi:[1,0,0]
    v_cvt_pk_f16_f32 v140, v144, v145
    v_cvt_pk_f16_f32 v141, v146, v147
    v_cvt_pk_f16_f32 v142, v148, v149
    v_cvt_pk_f16_f32 v143, v150, v151
    s_nop 1
    v_mfma_f32_16x16x32_f16 v[108:111], v[132:135], v[140:143], v[108:111]
    s_lshl_b32 s17, s27, 7
    s_lshl_b32 s18, s26, 2
    s_add_u32 s17, s17, s18
    s_add_u32 s17, s17, 65536
    s_waitcnt vmcnt(0)
    s_barrier
    s_cmp_lg_u32 s20, 1
    s_cbranch_scc1 S_nofx
    s_mov_b64 exec, 1
    buffer_atomic_swap v226, v227, s[4:7], s17 offen sc1
    s_mov_b64 exec, -1
S_nofx:
    s_setprio 0
    v_mul_f32 v144, v64, v204
    v_mul_f32 v146, v68, v204
    v_mul_f32 v148, v72, v204
    v_mul_f32 v150, v76, v204
    v_mul_f32 v145, v65, v204
    v_mul_f32 v147, v69, v204
    v_mul_f32 v149, v73, v204
    v_mul_f32 v151, v77, v204
    v_exp_f32 v144, v144
    v_exp_f32 v146, v146
    v_exp_f32 v148, v148
    v_exp_f32 v150, v150
    v_fract_f32 v145, v145
    v_fract_f32 v147, v147
    v_fract_f32 v149, v149
    v_fract_f32 v151, v151
    v_cos_f32 v112, v145
    v_cos_f32 v114, v147
    v_cos_f32 v116, v149
    v_cos_f32 v118, v151
    v_sin_f32 v113, v145
    v_sin_f32 v115, v147
    v_sin_f32 v117, v149
    v_sin_f32 v119, v151
    v_mul_f32 v112, v112, v144
    v_mul_f32 v114, v114, v146
    v_mul_f32 v116, v116, v148
    v_mul_f32 v118, v118, v150
    v_mul_f32 v113, v113, v144
    v_mul_f32 v115, v115, v146
    v_mul_f32 v117, v117, v148
    v_mul_f32 v119, v119, v150
    v_cvt_pk_f16_f32 v120, v112, v113
    v_cvt_pk_f16_f32 v121, v114, v115
    v_cvt_pk_f16_f32 v122, v116, v117
    v_cvt_pk_f16_f32 v123, v118, v119
    v_mul_f32 v144, v113, v113
    v_mul_f32 v146, v115, v115
    v_mul_f32 v148, v117, v117
    v_mul_f32 v150, v119, v119
    v_mul_f32_e64 v113, v112, v113 mul:2
    v_mul_f32_e64 v115, v114, v115 mul:2
    v_mul_f32_e64 v117, v116, v117 mul:2
    v_mul_f32_e64 v119, v118, v119 mul:2
    v_fma_f32 v112, v112, v112, -v144
    v_fma_f32 v114, v114, v114, -v146
    v_fma_f32 v116, v116, v116, -v148
    v_fma_f32 v118, v118, v118, -v150
    v_cvt_pk_f16_f32 v124, v112, v113
    v_cvt_pk_f16_f32 v125, v114, v115
    v_cvt_pk_f16_f32 v126, v116, v117
    v_cvt_pk_f16_f32 v127, v118, v119
    v_mul_f32 v144, v113, v113
    v_mul_f32 v146, v115, v115
    v_mul_f32 v148, v117, v117
    v_mul_f32 v150, v119, v119
    v_mul_f32_e64 v113, v112, v113 mul:2
    v_mul_f32_e64 v115, v114, v115 mul:2
    v_mul_f32_e64 v117, v116, v117 mul:2
    v_mul_f32_e64 v119, v118, v119 mul:2
    v_fma_f32 v112, v112, v112, -v144
    v_fma_f32 v114, v114, v114, -v146
    v_fma_f32 v116, v116, v116, -v148
    v_fma_f32 v118, v118, v118, -v150
    v_cvt_pk_f16_f32 v128, v112, v113
    v_cvt_pk_f16_f32 v129, v114, v115
    v_cvt_pk_f16_f32 v130, v116, v117
    v_cvt_pk_f16_f32 v131, v118, v119
    v_mul_f32 v144, v113, v113
    v_mul_f32 v146, v115, v115
    v_mul_f32 v148, v117, v117
    v_mul_f32 v150, v119, v119
    v_mul_f32_e64 v113, v112, v113 mul:2
    v_mul_f32_e64 v115, v114, v115 mul:2
    v_mul_f32_e64 v117, v116, v117 mul:2
    v_mul_f32_e64 v119, v118, v119 mul:2
    v_fma_f32 v112, v112, v112, -v144
    v_fma_f32 v114, v114, v114, -v146
    v_fma_f32 v116, v116, v116, -v148
    v_fma_f32 v118, v118, v118, -v150
    v_cvt_pk_f16_f32 v132, v112, v113
    v_cvt_pk_f16_f32 v133, v114, v115
    v_cvt_pk_f16_f32 v134, v116, v117
    v_cvt_pk_f16_f32 v135, v118, v119
    v_mul_f32 v144, v113, v113
    v_mul_f32 v146, v115, v115
    v_mul_f32 v148, v117, v117
    v_mul_f32 v150, v119, v119
    v_mul_f32_e64 v113, v112, v113 mul:2
    v_mul_f32_e64 v115, v114, v115 mul:2
    v_mul_f32_e64 v117, v116, v117 mul:2
    v_mul_f32_e64 v119, v118, v119 mul:2
    v_fma_f32 v112, v112, v112, -v144
    v_fma_f32 v114, v114, v114, -v146
    v_fma_f32 v116, v116, v116, -v148
    v_fma_f32 v118, v118, v118, -v150
    s_mov_b32 exec_lo, 0x80008000
    s_mov_b32 exec_hi, 0x80008000
    v_mov_b32 v112, 1.0
    v_mov_b32 v113, 0
    v_mov_b32 v114, 1.0
    v_mov_b32 v115, 0
    v_mov_b32 v116, 1.0
    v_mov_b32 v117, 0
    v_mov_b32 v118, 1.0
    v_mov_b32 v119, 0
    s_mov_b64 exec, -1
    v_mul_f32 v144, v67, v113
    v_mul_f32 v146, v71, v115
    v_mul_f32 v148, v75, v117
    v_mul_f32 v150, v79, v119
    v_mul_f32 v145, v67, v112
    v_mul_f32 v147, v71, v114
    v_mul_f32 v149, v75, v116
    v_mul_f32 v151, v79, v118
    v_fma_f32 v144, v66, v112, -v144
    v_fma_f32 v146, v70, v114, -v146
    v_fma_f32 v148, v74, v116, -v148
    v_fma_f32 v150, v78, v118, -v150
    v_fma_f32 v145, -v66, v113, -v145
    v_fma_f32 v147, -v70, v115, -v147
    v_fma_f32 v149, -v74, v117, -v149
    v_fma_f32 v151, -v78, v119, -v151
    v_cvt_pk_f16_f32 v136, v144, v145
    v_cvt_pk_f16_f32 v137, v146, v147
    v_cvt_pk_f16_f32 v138, v148, v149
    v_cvt_pk_f16_f32 v139, v150, v151
    v_mul_f32 v144, v113, v113
    v_mul_f32 v146, v115, v115
    v_mul_f32 v148, v117, v117
    v_mul_f32 v150, v119, v119
    v_mul_f32_e64 v113, v112, v113 mul:2
    v_mul_f32_e64 v115, v114, v115 mul:2
    v_mul_f32_e64 v117, v116, v117 mul:2
    v_mul_f32_e64 v119, v118, v119 mul:2
    v_fma_f32 v112, v112, v112, -v144
    v_fma_f32 v114, v114, v114, -v146
    v_fma_f32 v116, v116, v116, -v148
    v_fma_f32 v118, v118, v118, -v150
    v_mfma_f32_16x16x32_f16 v[96:99], v[120:123], v[136:139], v[96:99]
    v_mul_f32 v144, v67, v113
    v_mul_f32 v146, v71, v115
    v_mul_f32 v148, v75, v117
    v_mul_f32 v150, v79, v119
    v_mul_f32 v145, v67, v112
    v_mul_f32 v147, v71, v114
    v_mul_f32 v149, v75, v116
    v_mul_f32 v151, v79, v118
    v_fma_f32 v144, v66, v112, -v144
    v_fma_f32 v146, v70, v114, -v146
    v_fma_f32 v148, v74, v116, -v148
    v_fma_f32 v150, v78, v118, -v150
    v_fma_f32 v145, -v66, v113, -v145
    v_fma_f32 v147, -v70, v115, -v147
    v_fma_f32 v149, -v74, v117, -v149
    v_fma_f32 v151, -v78, v119, -v151
    v_cvt_pk_f16_f32 v140, v144, v145
    v_cvt_pk_f16_f32 v141, v146, v147
    v_cvt_pk_f16_f32 v142, v148, v149
    v_cvt_pk_f16_f32 v143, v150, v151
    v_mul_f32 v144, v113, v113
    v_mul_f32 v146, v115, v115
    v_mul_f32 v148, v117, v117
    v_mul_f32 v150, v119, v119
    v_mul_f32_e64 v113, v112, v113 mul:2
    v_mul_f32_e64 v115, v114, v115 mul:2
    v_mul_f32_e64 v117, v116, v117 mul:2
    v_mul_f32_e64 v119, v118, v119 mul:2
    v_fma_f32 v112, v112, v112, -v144
    v_fma_f32 v114, v114, v114, -v146
    v_fma_f32 v116, v116, v116, -v148
    v_fma_f32 v118, v118, v118, -v150
    v_mfma_f32_16x16x32_f16 v[100:103], v[124:127], v[140:143], v[100:103]
    v_mul_f32 v144, v67, v113
    v_mul_f32 v146, v71, v115
    v_mul_f32 v148, v75, v117
    v_mul_f32 v150, v79, v119
    v_mul_f32 v145, v67, v112
    v_mul_f32 v147, v71, v114
    v_mul_f32 v149, v75, v116
    v_mul_f32 v151, v79, v118
    v_fma_f32 v144, v66, v112, -v144
    v_fma_f32 v146, v70, v114, -v146
    v_fma_f32 v148, v74, v116, -v148
    v_fma_f32 v150, v78, v118, -v150
    v_fma_f32 v145, -v66, v113, -v145
    v_fma_f32 v147, -v70, v115, -v147
    v_fma_f32 v149, -v74, v117, -v149
    v_fma_f32 v151, -v78, v119, -v151
    v_cvt_pk_f16_f32 v136, v144, v145
    v_cvt_pk_f16_f32 v137, v146, v147
    v_cvt_pk_f16_f32 v138, v148, v149
    v_cvt_pk_f16_f32 v139, v150, v151
    v_mul_f32 v144, v113, v113
    v_mul_f32 v146, v115, v115
    v_mul_f32 v148, v117, v117
    v_mul_f32 v150, v119, v119
    v_mul_f32_e64 v113, v112, v113 mul:2
    v_mul_f32_e64 v115, v114, v115 mul:2
    v_mul_f32_e64 v117, v116, v117 mul:2
    v_mul_f32_e64 v119, v118, v119 mul:2
    v_fma_f32 v112, v112, v112, -v144
    v_fma_f32 v114, v114, v114, -v146
    v_fma_f32 v116, v116, v116, -v148
    v_fma_f32 v118, v118, v118, -v150
    v_mfma_f32_16x16x32_f16 v[104:107], v[128:131], v[136:139], v[104:107]
    v_mul_f32 v144, v67, v113
    v_mul_f32 v146, v71, v115
    v_mul_f32 v148, v75, v117
    v_mul_f32 v150, v79, v119
    v_mul_f32 v145, v67, v112
    v_mul_f32 v147, v71, v114
    v_mul_f32 v149, v75, v116
    v_mul_f32 v151, v79, v118
    v_fma_f32 v144, v66, v112, -v144
    v_fma_f32 v146, v70, v114, -v146
    v_fma_f32 v148, v74, v116, -v148
    v_fma_f32 v150, v78, v118, -v150
    v_fma_f32 v145, -v66, v113, -v145
    v_fma_f32 v147, -v70, v115, -v147
    v_fma_f32 v149, -v74, v117, -v149
    v_fma_f32 v151, -v78, v119, -v151
    v_cvt_pk_f16_f32 v140, v144, v145
    v_cvt_pk_f16_f32 v141, v146, v147
    v_cvt_pk_f16_f32 v142, v148, v149
    v_cvt_pk_f16_f32 v143, v150, v151
    s_nop 1
    v_mfma_f32_16x16x32_f16 v[108:111], v[132:135], v[140:143], v[108:111]
    s_lshr_b32 s17, s3, 4
    s_lshl_b32 s17, s17, 7
    s_add_u32 s17, s17, 65536
    v_mul_f32 v144, v80, v204
    v_mul_f32 v146, v84, v204
    v_mul_f32 v148, v88, v204
    v_mul_f32 v150, v92, v204
    v_mul_f32 v145, v81, v204
    v_mul_f32 v147, v85, v204
    v_mul_f32 v149, v89, v204
    v_mul_f32 v151, v93, v204
    v_exp_f32 v144, v144
    v_exp_f32 v146, v146
    v_exp_f32 v148, v148
    v_exp_f32 v150, v150
    v_fract_f32 v145, v145
    v_fract_f32 v147, v147
    v_fract_f32 v149, v149
    v_fract_f32 v151, v151
    v_cos_f32 v112, v145
    v_cos_f32 v114, v147
    v_cos_f32 v116, v149
    v_cos_f32 v118, v151
    v_sin_f32 v113, v145
    v_sin_f32 v115, v147
    v_sin_f32 v117, v149
    v_sin_f32 v119, v151
    v_mul_f32 v112, v112, v144
    v_mul_f32 v114, v114, v146
    v_mul_f32 v116, v116, v148
    v_mul_f32 v118, v118, v150
    v_mul_f32 v113, v113, v144
    v_mul_f32 v115, v115, v146
    v_mul_f32 v117, v117, v148
    v_mul_f32 v119, v119, v150
    v_cvt_pk_f16_f32 v120, v112, v113
    v_cvt_pk_f16_f32 v121, v114, v115
    v_cvt_pk_f16_f32 v122, v116, v117
    v_cvt_pk_f16_f32 v123, v118, v119
    v_mul_f32 v144, v113, v113
    v_mul_f32 v146, v115, v115
    v_mul_f32 v148, v117, v117
    v_mul_f32 v150, v119, v119
    v_mul_f32_e64 v113, v112, v113 mul:2
    v_mul_f32_e64 v115, v114, v115 mul:2
    v_mul_f32_e64 v117, v116, v117 mul:2
    v_mul_f32_e64 v119, v118, v119 mul:2
    v_fma_f32 v112, v112, v112, -v144
    v_fma_f32 v114, v114, v114, -v146
    v_fma_f32 v116, v116, v116, -v148
    v_fma_f32 v118, v118, v118, -v150
    v_cvt_pk_f16_f32 v124, v112, v113
    v_cvt_pk_f16_f32 v125, v114, v115
    v_cvt_pk_f16_f32 v126, v116, v117
    v_cvt_pk_f16_f32 v127, v118, v119
    v_mul_f32 v144, v113, v113
    v_mul_f32 v146, v115, v115
    v_mul_f32 v148, v117, v117
    v_mul_f32 v150, v119, v119
    v_mul_f32_e64 v113, v112, v113 mul:2
    v_mul_f32_e64 v115, v114, v115 mul:2
    v_mul_f32_e64 v117, v116, v117 mul:2
    v_mul_f32_e64 v119, v118, v119 mul:2
    v_fma_f32 v112, v112, v112, -v144
    v_fma_f32 v114, v114, v114, -v146
    v_fma_f32 v116, v116, v116, -v148
    v_fma_f32 v118, v118, v118, -v150
    v_cvt_pk_f16_f32 v128, v112, v113
    v_cvt_pk_f16_f32 v129, v114, v115
    v_cvt_pk_f16_f32 v130, v116, v117
    v_cvt_pk_f16_f32 v131, v118, v119
    v_mul_f32 v144, v113, v113
    v_mul_f32 v146, v115, v115
    v_mul_f32 v148, v117, v117
    v_mul_f32 v150, v119, v119
    v_mul_f32_e64 v113, v112, v113 mul:2
    v_mul_f32_e64 v115, v114, v115 mul:2
    v_mul_f32_e64 v117, v116, v117 mul:2
    v_mul_f32_e64 v119, v118, v119 mul:2
    v_fma_f32 v112, v112, v112, -v144
    v_fma_f32 v114, v114, v114, -v146
    v_fma_f32 v116, v116, v116, -v148
    v_fma_f32 v118, v118, v118, -v150
    v_cvt_pk_f16_f32 v132, v112, v113
    v_cvt_pk_f16_f32 v133, v114, v115
    v_cvt_pk_f16_f32 v134, v116, v117
    v_cvt_pk_f16_f32 v135, v118, v119
    v_mul_f32 v144, v113, v113
    v_mul_f32 v146, v115, v115
    v_mul_f32 v148, v117, v117
    v_mul_f32 v150, v119, v119
    v_mul_f32_e64 v113, v112, v113 mul:2
    v_mul_f32_e64 v115, v114, v115 mul:2
    v_mul_f32_e64 v117, v116, v117 mul:2
    v_mul_f32_e64 v119, v118, v119 mul:2
    v_fma_f32 v112, v112, v112, -v144
    v_fma_f32 v114, v114, v114, -v146
    v_fma_f32 v116, v116, v116, -v148
    v_fma_f32 v118, v118, v118, -v150
    s_mov_b32 exec_lo, 0x80008000
    s_mov_b32 exec_hi, 0x80008000
    v_mov_b32 v112, 1.0
    v_mov_b32 v113, 0
    v_mov_b32 v114, 1.0
    v_mov_b32 v115, 0
    v_mov_b32 v116, 1.0
    v_mov_b32 v117, 0
    v_mov_b32 v118, 1.0
    v_mov_b32 v119, 0
    s_mov_b64 exec, -1
    v_mul_f32 v144, v83, v113
    v_mul_f32 v146, v87, v115
    v_mul_f32 v148, v91, v117
    v_mul_f32 v150, v95, v119
    v_mul_f32 v145, v83, v112
    v_mul_f32 v147, v87, v114
    v_mul_f32 v149, v91, v116
    v_mul_f32 v151, v95, v118
    v_fma_f32 v144, v82, v112, -v144
    v_fma_f32 v146, v86, v114, -v146
    v_fma_f32 v148, v90, v116, -v148
    v_fma_f32 v150, v94, v118, -v150
    v_fma_f32 v145, -v82, v113, -v145
    v_fma_f32 v147, -v86, v115, -v147
    v_fma_f32 v149, -v90, v117, -v149
    v_fma_f32 v151, -v94, v119, -v151
    v_cvt_pk_f16_f32 v136, v144, v145
    v_cvt_pk_f16_f32 v137, v146, v147
    v_cvt_pk_f16_f32 v138, v148, v149
    v_cvt_pk_f16_f32 v139, v150, v151
    v_mul_f32 v144, v113, v113
    v_mul_f32 v146, v115, v115
    v_mul_f32 v148, v117, v117
    v_mul_f32 v150, v119, v119
    v_mul_f32_e64 v113, v112, v113 mul:2
    v_mul_f32_e64 v115, v114, v115 mul:2
    v_mul_f32_e64 v117, v116, v117 mul:2
    v_mul_f32_e64 v119, v118, v119 mul:2
    v_fma_f32 v112, v112, v112, -v144
    v_fma_f32 v114, v114, v114, -v146
    v_fma_f32 v116, v116, v116, -v148
    v_fma_f32 v118, v118, v118, -v150
    v_mfma_f32_16x16x32_f16 v[96:99], v[120:123], v[136:139], v[96:99]
    v_mul_f32 v144, v83, v113
    v_mul_f32 v146, v87, v115
    v_mul_f32 v148, v91, v117
    v_mul_f32 v150, v95, v119
    v_mul_f32 v145, v83, v112
    v_mul_f32 v147, v87, v114
    v_mul_f32 v149, v91, v116
    v_mul_f32 v151, v95, v118
    v_fma_f32 v144, v82, v112, -v144
    v_fma_f32 v146, v86, v114, -v146
    v_fma_f32 v148, v90, v116, -v148
    v_fma_f32 v150, v94, v118, -v150
    v_fma_f32 v145, -v82, v113, -v145
    v_fma_f32 v147, -v86, v115, -v147
    v_fma_f32 v149, -v90, v117, -v149
    v_fma_f32 v151, -v94, v119, -v151
    v_cvt_pk_f16_f32 v140, v144, v145
    v_cvt_pk_f16_f32 v141, v146, v147
    v_cvt_pk_f16_f32 v142, v148, v149
    v_cvt_pk_f16_f32 v143, v150, v151
    v_mul_f32 v144, v113, v113
    v_mul_f32 v146, v115, v115
    v_mul_f32 v148, v117, v117
    v_mul_f32 v150, v119, v119
    v_mul_f32_e64 v113, v112, v113 mul:2
    v_mul_f32_e64 v115, v114, v115 mul:2
    v_mul_f32_e64 v117, v116, v117 mul:2
    v_mul_f32_e64 v119, v118, v119 mul:2
    v_fma_f32 v112, v112, v112, -v144
    v_fma_f32 v114, v114, v114, -v146
    v_fma_f32 v116, v116, v116, -v148
    v_fma_f32 v118, v118, v118, -v150
    v_mfma_f32_16x16x32_f16 v[100:103], v[124:127], v[140:143], v[100:103]
    v_mul_f32 v144, v83, v113
    v_mul_f32 v146, v87, v115
    v_mul_f32 v148, v91, v117
    v_mul_f32 v150, v95, v119
    v_mul_f32 v145, v83, v112
    v_mul_f32 v147, v87, v114
    v_mul_f32 v149, v91, v116
    v_mul_f32 v151, v95, v118
    v_fma_f32 v144, v82, v112, -v144
    v_fma_f32 v146, v86, v114, -v146
    v_fma_f32 v148, v90, v116, -v148
    v_fma_f32 v150, v94, v118, -v150
    v_fma_f32 v145, -v82, v113, -v145
    v_fma_f32 v147, -v86, v115, -v147
    v_fma_f32 v149, -v90, v117, -v149
    v_fma_f32 v151, -v94, v119, -v151
    v_cvt_pk_f16_f32 v136, v144, v145
    v_cvt_pk_f16_f32 v137, v146, v147
    v_cvt_pk_f16_f32 v138, v148, v149
    v_cvt_pk_f16_f32 v139, v150, v151
    v_mul_f32 v144, v113, v113
    v_mul_f32 v146, v115, v115
    v_mul_f32 v148, v117, v117
    v_mul_f32 v150, v119, v119
    v_mul_f32_e64 v113, v112, v113 mul:2
    v_mul_f32_e64 v115, v114, v115 mul:2
    v_mul_f32_e64 v117, v116, v117 mul:2
    v_mul_f32_e64 v119, v118, v119 mul:2
    v_fma_f32 v112, v112, v112, -v144
    v_fma_f32 v114, v114, v114, -v146
    v_fma_f32 v116, v116, v116, -v148
    v_fma_f32 v118, v118, v118, -v150
    v_mfma_f32_16x16x32_f16 v[104:107], v[128:131], v[136:139], v[104:107]
    v_mul_f32 v144, v83, v113
    v_mul_f32 v146, v87, v115
    v_mul_f32 v148, v91, v117
    v_mul_f32 v150, v95, v119
    v_mul_f32 v145, v83, v112
    v_mul_f32 v147, v87, v114
    v_mul_f32 v149, v91, v116
    v_mul_f32 v151, v95, v118
    v_fma_f32 v144, v82, v112, -v144
    v_fma_f32 v146, v86, v114, -v146
    v_fma_f32 v148, v90, v116, -v148
    v_fma_f32 v150, v94, v118, -v150
    v_fma_f32 v145, -v82, v113, -v145
    v_fma_f32 v147, -v86, v115, -v147
    v_fma_f32 v149, -v90, v117, -v149
    v_fma_f32 v151, -v94, v119, -v151
    v_cvt_pk_f16_f32 v140, v144, v145
    v_cvt_pk_f16_f32 v141, v146, v147
    v_cvt_pk_f16_f32 v142, v148, v149
    v_cvt_pk_f16_f32 v143, v150, v151
    s_nop 1
    v_mfma_f32_16x16x32_f16 v[108:111], v[132:135], v[140:143], v[108:111]
    s_setprio 0
    buffer_load_dword v19, v218, s[4:7], s17 offen sc1
    v_ldexp_f32 v96, v96, v248
    v_ldexp_f32 v97, v97, v248
    v_ldexp_f32 v98, v98, v248
    v_ldexp_f32 v99, v99, v248
    v_ldexp_f32 v100, v100, v248
    v_ldexp_f32 v101, v101, v248
    v_ldexp_f32 v102, v102, v248
    v_ldexp_f32 v103, v103, v248
    v_ldexp_f32 v104, v104, v248
    v_ldexp_f32 v105, v105, v248
    v_ldexp_f32 v106, v106, v248
    v_ldexp_f32 v107, v107, v248
    v_ldexp_f32 v108, v108, v248
    v_ldexp_f32 v109, v109, v248
    v_ldexp_f32 v110, v110, v248
    v_ldexp_f32 v111, v111, v248
    s_cmp_eq_u32 s22, 0
    s_cbranch_scc0 S_mh1
    ds_write_b128 v212, v[104:107] offset:0
    ds_write_b128 v212, v[108:111] offset:1024
    s_waitcnt lgkmcnt(0)
    s_barrier
    ds_read_b128 v[32:35], v213 offset:0
    ds_read_b128 v[36:39], v213 offset:1024
    s_waitcnt lgkmcnt(0)
    v_add_f32 v32, v32, v96
    v_add_f32 v33, v33, v97
    v_add_f32 v34, v34, v98
    v_add_f32 v35, v35, v99
    v_cvt_pk_f16_f32 v44, v32, v33
    v_cvt_pk_f16_f32 v45, v34, v35
    v_add_f32 v36, v36, v100
    v_add_f32 v37, v37, v101
    v_add_f32 v38, v38, v102
    v_add_f32 v39, v39, v103
    v_cvt_pk_f16_f32 v46, v36, v37
    v_cvt_pk_f16_f32 v47, v38, v39
    v_cvt_pk_f16_f32 v40, v250, v250
    v_mov_b32 v41, s32
    ds_write_b16 v41, v40 offset:6
    ds_write_b64 v215, v[44:45] offset:8
    s_mov_b32 exec_lo, 0x7f807f80
    s_mov_b32 exec_hi, 0x7f807f80
    ds_write_b64 v215, v[46:47] offset:264
    s_mov_b64 exec, -1
    s_branch S_join
S_mh1:
    ds_write_b128 v212, v[96:99] offset:0
    ds_write_b128 v212, v[100:103] offset:1024
    s_waitcnt lgkmcnt(0)
    s_barrier
    ds_read_b128 v[32:35], v213 offset:0
    ds_read_b128 v[36:39], v213 offset:1024
    s_waitcnt lgkmcnt(0)
    v_add_f32 v32, v32, v104
    v_add_f32 v33, v33, v105
    v_add_f32 v34, v34, v106
    v_add_f32 v35, v35, v107
    v_cvt_pk_f16_f32 v44, v32, v33
    v_cvt_pk_f16_f32 v45, v34, v35
    v_add_f32 v36, v36, v108
    v_add_f32 v37, v37, v109
    v_add_f32 v38, v38, v110
    v_add_f32 v39, v39, v111
    v_cvt_pk_f16_f32 v46, v36, v37
    v_cvt_pk_f16_f32 v47, v38, v39
    s_mov_b32 exec_lo, 0x7f807f80
    s_mov_b32 exec_hi, 0x7f807f80
    ds_write_b64 v215, v[44:45] offset:520
    ds_write_b64 v215, v[46:47] offset:776
    s_mov_b64 exec, -1
S_join:
    s_waitcnt vmcnt(0)
    v_cmp_ne_u32 vcc, v19, v226
    s_nop 3
    s_cbranch_vccz S_fx_ok
    s_mov_b32 s12, 0
    s_sleep 6
S_fx_poll:
    buffer_load_dword v19, v218, s[4:7], s17 offen sc1
    s_add_u32 s12, s12, 1
    s_waitcnt vmcnt(0)
    v_cmp_ne_u32 vcc, v19, v226
    s_nop 3
    s_cbranch_vccz S_fx_ok
    s_cmp_gt_u32 s12, 200000
    s_cbranch_scc1 S_fx_ok
    s_sleep 6
    s_branch S_fx_poll
S_fx_ok:
    buffer_load_dwordx2 v[160:161], v3, s[4:7], s24 offen offset:8 sc1
    buffer_load_dwordx4 v[162:165], v3, s[4:7], s24 offen offset:16 sc1
    buffer_load_dwordx2 v[166:167], v3, s[4:7], s24 offen offset:1032 sc1
    buffer_load_dwordx4 v[168:171], v3, s[4:7], s24 offen offset:1040 sc1
    s_mov_b64 exec, 3
    buffer_load_dwordx2 v[172:173], v3, s[4:7], s24 offen offset:2056 sc1
    buffer_load_dwordx4 v[174:177], v3, s[4:7], s24 offen offset:2064 sc1
    s_mov_b64 exec, -1
    s_waitcnt lgkmcnt(0)
    s_barrier
    ds_read_u16 v80, v232
    ds_read_u16 v81, v233
    ds_read_u16 v82, v234
    ds_read_u16 v83, v235
    ds_read_u16 v84, v236
    ds_read_u16 v85, v237
    ds_read_u16 v86, v238
    ds_read_u16 v87, v239
    ds_read_u16 v88, v240
    ds_read_u16 v89, v241
    ds_read_u16 v90, v242
    ds_read_u16 v91, v243
    s_waitcnt lgkmcnt(4)
    ds_read_u16 v92, v244
    ds_read_u16 v93, v245
    ds_read_u16 v94, v246
    ds_read_u16 v95, v247
    s_waitcnt lgkmcnt(0)
    v_lshl_or_b32 v96, v82, 16, v83
    v_lshl_or_b32 v97, v80, 16, v81
    ds_write_b64 v217, v[96:97] offset:3072
    ds_write_b64 v217, v[96:97] offset:7720
    v_lshl_or_b32 v98, v86, 16, v87
    v_lshl_or_b32 v99, v84, 16, v85
    ds_write_b64 v217, v[98:99] offset:2048
    ds_write_b64 v217, v[98:99] offset:6696
    v_lshl_or_b32 v100, v90, 16, v91
    v_lshl_or_b32 v101, v88, 16, v89
    ds_write_b64 v217, v[100:101] offset:1024
    ds_write_b64 v217, v[100:101] offset:5672
    v_lshl_or_b32 v102, v94, 16, v95
    v_lshl_or_b32 v103, v92, 16, v93
    ds_write_b64 v217, v[102:103] offset:0
    ds_write_b64 v217, v[102:103] offset:4648
    s_waitcnt vmcnt(4)
    v_alignbyte_b32 v180, v161, v160, 2
    v_alignbyte_b32 v181, v162, v161, 2
    v_alignbyte_b32 v182, v163, v162, 2
    v_alignbyte_b32 v183, v164, v163, 2
    v_mov_b32 v184, v161
    v_mov_b32 v185, v162
    v_mov_b32 v186, v163
    v_mov_b32 v187, v164
    v_alignbyte_b32 v188, v162, v161, 2
    v_alignbyte_b32 v189, v163, v162, 2
    v_alignbyte_b32 v190, v164, v163, 2
    v_alignbyte_b32 v191, v165, v164, 2
    ds_write_b128 v219, v[162:165] offset:12480
    ds_write_b128 v219, v[180:183] offset:0
    ds_write_b128 v219, v[184:187] offset:4160
    ds_write_b128 v219, v[188:191] offset:8320
    s_waitcnt vmcnt(2)
    v_alignbyte_b32 v192, v167, v166, 2
    v_alignbyte_b32 v193, v168, v167, 2
    v_alignbyte_b32 v194, v169, v168, 2
    v_alignbyte_b32 v195, v170, v169, 2
    v_mov_b32 v196, v167
    v_mov_b32 v197, v168
    v_mov_b32 v198, v169
    v_mov_b32 v199, v170
    v_alignbyte_b32 v200, v168, v167, 2
    v_alignbyte_b32 v201, v169, v168, 2
    v_alignbyte_b32 v202, v170, v169, 2
    v_alignbyte_b32 v203, v171, v170, 2
    ds_write_b128 v219, v[168:171] offset:13504
    ds_write_b128 v219, v[192:195] offset:1024
    ds_write_b128 v219, v[196:199] offset:5184
    ds_write_b128 v219, v[200:203] offset:9344
    s_waitcnt lgkmcnt(4)
    s_waitcnt vmcnt(0)
    s_mov_b64 exec, 3
    v_alignbyte_b32 v180, v173, v172, 2
    v_alignbyte_b32 v181, v174, v173, 2
    v_alignbyte_b32 v182, v175, v174, 2
    v_alignbyte_b32 v183, v176, v175, 2
    v_mov_b32 v184, v173
    v_mov_b32 v185, v174
    v_mov_b32 v186, v175
    v_mov_b32 v187, v176
    v_alignbyte_b32 v188, v174, v173, 2
    v_alignbyte_b32 v189, v175, v174, 2
    v_alignbyte_b32 v190, v176, v175, 2
    v_alignbyte_b32 v191, v177, v176, 2
    ds_write_b128 v219, v[174:177] offset:14528
    ds_write_b128 v219, v[180:183] offset:2048
    ds_write_b128 v219, v[184:187] offset:6208
    ds_write_b128 v219, v[188:191] offset:10368
    s_mov_b64 exec, -1
    s_waitcnt lgkmcnt(0)
    s_barrier
    s_setprio 0
    ds_read_b128 v[64:67], v220 offset:0
    ds_read_b128 v[96:99], v221 offset:3584
    ds_read_b128 v[68:71], v220 offset:512
    ds_read_b128 v[100:103], v221 offset:3072
    ds_read_b128 v[72:75], v220 offset:1024
    ds_read_b128 v[104:107], v221 offset:2560
    ds_read_b128 v[76:79], v220 offset:1536
    ds_read_b128 v[108:111], v221 offset:2048
    ds_read_b128 v[80:83], v220 offset:2048
    ds_read_b128 v[112:115], v221 offset:1536
    ds_read_b128 v[84:87], v220 offset:2560
    ds_read_b128 v[116:119], v221 offset:1024
    ds_read_b128 v[88:91], v220 offset:3072
    ds_read_b128 v[120:123], v221 offset:512
    s_waitcnt lgkmcnt(12)
    v_mfma_f32_16x16x32_f16 v[32:35], v[64:67], v[96:99], 0
    ds_read_b128 v[92:95], v220 offset:3584
    ds_read_b128 v[124:127], v221 offset:0
    s_waitcnt lgkmcnt(12)
    v_mfma_f32_16x16x32_f16 v[36:39], v[64:67], v[100:103], 0
    v_mfma_f32_16x16x32_f16 v[36:39], v[68:71], v[96:99], v[36:39]
    v_mfma_f32_16x16x32_f16 v[40:43], v[68:71], v[100:103], 0
    s_waitcnt lgkmcnt(10)
    v_mfma_f32_16x16x32_f16 v[40:43], v[64:67], v[104:107], v[40:43]
    v_mfma_f32_16x16x32_f16 v[44:47], v[68:71], v[104:107], 0
    v_mfma_f32_16x16x32_f16 v[40:43], v[72:75], v[96:99], v[40:43]
    v_mfma_f32_16x16x32_f16 v[44:47], v[72:75], v[100:103], v[44:47]
    v_mfma_f32_16x16x32_f16 v[48:51], v[72:75], v[104:107], 0
    s_waitcnt lgkmcnt(8)
    v_mfma_f32_16x16x32_f16 v[44:47], v[64:67], v[108:111], v[44:47]
    v_mfma_f32_16x16x32_f16 v[48:51], v[68:71], v[108:111], v[48:51]
    v_mfma_f32_16x16x32_f16 v[52:55], v[72:75], v[108:111], 0
    v_mfma_f32_16x16x32_f16 v[44:47], v[76:79], v[96:99], v[44:47]
    v_mfma_f32_16x16x32_f16 v[48:51], v[76:79], v[100:103], v[48:51]
    v_mfma_f32_16x16x32_f16 v[52:55], v[76:79], v[104:107], v[52:55]
    v_mfma_f32_16x16x32_f16 v[56:59], v[76:79], v[108:111], 0
    s_waitcnt lgkmcnt(6)
    v_mfma_f32_16x16x32_f16 v[48:51], v[64:67], v[112:115], v[48:51]
    v_mfma_f32_16x16x32_f16 v[52:55], v[68:71], v[112:115], v[52:55]
    v_mfma_f32_16x16x32_f16 v[56:59], v[72:75], v[112:115], v[56:59]
    v_mfma_f32_16x16x32_f16 v[60:63], v[76:79], v[112:115], 0
    v_mfma_f32_16x16x32_f16 v[48:51], v[80:83], v[96:99], v[48:51]
    v_mfma_f32_16x16x32_f16 v[52:55], v[80:83], v[100:103], v[52:55]
    v_mfma_f32_16x16x32_f16 v[56:59], v[80:83], v[104:107], v[56:59]
    v_mfma_f32_16x16x32_f16 v[60:63], v[80:83], v[108:111], v[60:63]
    s_waitcnt lgkmcnt(0)
    v_mfma_f32_16x16x32_f16 v[52:55], v[64:67], v[116:119], v[52:55]
    ds_read_b128 v[128:131], v220 offset:64
    ds_read_b128 v[160:163], v221 offset:3648
    v_mfma_f32_16x16x32_f16 v[56:59], v[68:71], v[116:119], v[56:59]
    ds_read_b128 v[132:135], v220 offset:576
    ds_read_b128 v[164:167], v221 offset:3136
    v_mfma_f32_16x16x32_f16 v[60:63], v[72:75], v[116:119], v[60:63]
    ds_read_b128 v[136:139], v220 offset:1088
    ds_read_b128 v[168:171], v221 offset:2624
    v_mfma_f32_16x16x32_f16 v[52:55], v[84:87], v[96:99], v[52:55]
    ds_read_b128 v[140:143], v220 offset:1600
    ds_read_b128 v[172:175], v221 offset:2112
    v_mfma_f32_16x16x32_f16 v[56:59], v[84:87], v[100:103], v[56:59]
    ds_read_b128 v[144:147], v220 offset:2112
    ds_read_b128 v[176:179], v221 offset:1600
    v_mfma_f32_16x16x32_f16 v[60:63], v[84:87], v[104:107], v[60:63]
    ds_read_b128 v[148:151], v220 offset:2624
    ds_read_b128 v[180:183], v221 offset:1088
    v_mfma_f32_16x16x32_f16 v[56:59], v[64:67], v[120:123], v[56:59]
    ds_read_b128 v[152:155], v220 offset:3136
    ds_read_b128 v[184:187], v221 offset:576
    v_mfma_f32_16x16x32_f16 v[60:63], v[68:71], v[120:123], v[60:63]
    ds_read_b128 v[156:159], v220 offset:3648
    v_mfma_f32_16x16x32_f16 v[56:59], v[88:91], v[96:99], v[56:59]
    v_mfma_f32_16x16x32_f16 v[60:63], v[88:91], v[100:103], v[60:63]
    v_mfma_f32_16x16x32_f16 v[60:63], v[64:67], v[124:127], v[60:63]
    v_mfma_f32_16x16x32_f16 v[60:63], v[92:95], v[96:99], v[60:63]
    s_waitcnt lgkmcnt(4)
    ds_read_b128 v[188:191], v221 offset:64
    s_waitcnt lgkmcnt(0)
    v_mfma_f32_16x16x32_f16 v[32:35], v[128:131], v[160:163], v[32:35]
    ds_read_b128 v[64:67], v220 offset:128
    v_mfma_f32_16x16x32_f16 v[36:39], v[128:131], v[164:167], v[36:39]
    v_mfma_f32_16x16x32_f16 v[36:39], v[132:135], v[160:163], v[36:39]
    ds_read_b128 v[96:99], v221 offset:3712
    v_mfma_f32_16x16x32_f16 v[40:43], v[132:135], v[164:167], v[40:43]
    v_mfma_f32_16x16x32_f16 v[40:43], v[128:131], v[168:171], v[40:43]
    ds_read_b128 v[68:71], v220 offset:640
    v_mfma_f32_16x16x32_f16 v[44:47], v[132:135], v[168:171], v[44:47]
    v_mfma_f32_16x16x32_f16 v[40:43], v[136:139], v[160:163], v[40:43]
    ds_read_b128 v[100:103], v221 offset:3200
    v_mfma_f32_16x16x32_f16 v[44:47], v[136:139], v[164:167], v[44:47]
    v_mfma_f32_16x16x32_f16 v[48:51], v[136:139], v[168:171], v[48:51]
    ds_read_b128 v[72:75], v220 offset:1152
    v_mfma_f32_16x16x32_f16 v[44:47], v[128:131], v[172:175], v[44:47]
    v_mfma_f32_16x16x32_f16 v[48:51], v[132:135], v[172:175], v[48:51]
    ds_read_b128 v[104:107], v221 offset:2688
    v_mfma_f32_16x16x32_f16 v[52:55], v[136:139], v[172:175], v[52:55]
    v_mfma_f32_16x16x32_f16 v[44:47], v[140:143], v[160:163], v[44:47]
    ds_read_b128 v[76:79], v220 offset:1664
    v_mfma_f32_16x16x32_f16 v[48:51], v[140:143], v[164:167], v[48:51]
    v_mfma_f32_16x16x32_f16 v[52:55], v[140:143], v[168:171], v[52:55]
    ds_read_b128 v[108:111], v221 offset:2176
    v_mfma_f32_16x16x32_f16 v[56:59], v[140:143], v[172:175], v[56:59]
    v_mfma_f32_16x16x32_f16 v[48:51], v[128:131], v[176:179], v[48:51]
    ds_read_b128 v[80:83], v220 offset:2176
    v_mfma_f32_16x16x32_f16 v[52:55], v[132:135], v[176:179], v[52:55]
    v_mfma_f32_16x16x32_f16 v[56:59], v[136:139], v[176:179], v[56:59]
    ds_read_b128 v[112:115], v221 offset:1664
    v_mfma_f32_16x16x32_f16 v[60:63], v[140:143], v[176:179], v[60:63]
    v_mfma_f32_16x16x32_f16 v[48:51], v[144:147], v[160:163], v[48:51]
    ds_read_b128 v[84:87], v220 offset:2688
    v_mfma_f32_16x16x32_f16 v[52:55], v[144:147], v[164:167], v[52:55]
    v_mfma_f32_16x16x32_f16 v[56:59], v[144:147], v[168:171], v[56:59]
    ds_read_b128 v[116:119], v221 offset:1152
    v_mfma_f32_16x16x32_f16 v[60:63], v[144:147], v[172:175], v[60:63]
    v_mfma_f32_16x16x32_f16 v[52:55], v[128:131], v[180:183], v[52:55]
    ds_read_b128 v[88:91], v220 offset:3200
    v_mfma_f32_16x16x32_f16 v[56:59], v[132:135], v[180:183], v[56:59]
    v_mfma_f32_16x16x32_f16 v[60:63], v[136:139], v[180:183], v[60:63]
    ds_read_b128 v[120:123], v221 offset:640
    v_mfma_f32_16x16x32_f16 v[52:55], v[148:151], v[160:163], v[52:55]
    v_mfma_f32_16x16x32_f16 v[56:59], v[148:151], v[164:167], v[56:59]
    ds_read_b128 v[92:95], v220 offset:3712
    v_mfma_f32_16x16x32_f16 v[60:63], v[148:151], v[168:171], v[60:63]
    v_mfma_f32_16x16x32_f16 v[56:59], v[128:131], v[184:187], v[56:59]
    v_mfma_f32_16x16x32_f16 v[60:63], v[132:135], v[184:187], v[60:63]
    v_mfma_f32_16x16x32_f16 v[56:59], v[152:155], v[160:163], v[56:59]
    v_mfma_f32_16x16x32_f16 v[60:63], v[152:155], v[164:167], v[60:63]
    v_mfma_f32_16x16x32_f16 v[60:63], v[128:131], v[188:191], v[60:63]
    v_mfma_f32_16x16x32_f16 v[60:63], v[156:159], v[160:163], v[60:63]
    s_waitcnt lgkmcnt(4)
    ds_read_b128 v[124:127], v221 offset:128
    s_waitcnt lgkmcnt(0)
    v_mfma_f32_16x16x32_f16 v[32:35], v[64:67], v[96:99], v[32:35]
    ds_read_b128 v[128:131], v220 offset:192
    v_mfma_f32_16x16x32_f16 v[36:39], v[64:67], v[100:103], v[36:39]
    v_mfma_f32_16x16x32_f16 v[36:39], v[68:71], v[96:99], v[36:39]
    ds_read_b128 v[160:163], v221 offset:3776
    v_mfma_f32_16x16x32_f16 v[40:43], v[68:71], v[100:103], v[40:43]
    v_mfma_f32_16x16x32_f16 v[40:43], v[64:67], v[104:107], v[40:43]
    ds_read_b128 v[132:135], v220 offset:704
    v_mfma_f32_16x16x32_f16 v[44:47], v[68:71], v[104:107], v[44:47]
    v_mfma_f32_16x16x32_f16 v[40:43], v[72:75], v[96:99], v[40:43]
    ds_read_b128 v[164:167], v221 offset:3264
    v_mfma_f32_16x16x32_f16 v[44:47], v[72:75], v[100:103], v[44:47]
    v_mfma_f32_16x16x32_f16 v[48:51], v[72:75], v[104:107], v[48:51]
    ds_read_b128 v[136:139], v220 offset:1216
    v_mfma_f32_16x16x32_f16 v[44:47], v[64:67], v[108:111], v[44:47]
    v_mfma_f32_16x16x32_f16 v[48:51], v[68:71], v[108:111], v[48:51]
    ds_read_b128 v[168:171], v221 offset:2752
    v_mfma_f32_16x16x32_f16 v[52:55], v[72:75], v[108:111], v[52:55]
    v_mfma_f32_16x16x32_f16 v[44:47], v[76:79], v[96:99], v[44:47]
    ds_read_b128 v[140:143], v220 offset:1728
    v_mfma_f32_16x16x32_f16 v[48:51], v[76:79], v[100:103], v[48:51]
    v_mfma_f32_16x16x32_f16 v[52:55], v[76:79], v[104:107], v[52:55]
    ds_read_b128 v[172:175], v221 offset:2240
    v_mfma_f32_16x16x32_f16 v[56:59], v[76:79], v[108:111], v[56:59]
    v_mfma_f32_16x16x32_f16 v[48:51], v[64:67], v[112:115], v[48:51]
    ds_read_b128 v[144:147], v220 offset:2240
    v_mfma_f32_16x16x32_f16 v[52:55], v[68:71], v[112:115], v[52:55]
    v_mfma_f32_16x16x32_f16 v[56:59], v[72:75], v[112:115], v[56:59]
    ds_read_b128 v[176:179], v221 offset:1728
    v_mfma_f32_16x16x32_f16 v[60:63], v[76:79], v[112:115], v[60:63]
    v_mfma_f32_16x16x32_f16 v[48:51], v[80:83], v[96:99], v[48:51]
    ds_read_b128 v[148:151], v220 offset:2752
    v_mfma_f32_16x16x32_f16 v[52:55], v[80:83], v[100:103], v[52:55]
    v_mfma_f32_16x16x32_f16 v[56:59], v[80:83], v[104:107], v[56:59]
    ds_read_b128 v[180:183], v221 offset:1216
    v_mfma_f32_16x16x32_f16 v[60:63], v[80:83], v[108:111], v[60:63]
    v_mfma_f32_16x16x32_f16 v[52:55], v[64:67], v[116:119], v[52:55]
    ds_read_b128 v[152:155], v220 offset:3264
    v_mfma_f32_16x16x32_f16 v[56:59], v[68:71], v[116:119], v[56:59]
    v_mfma_f32_16x16x32_f16 v[60:63], v[72:75], v[116:119], v[60:63]
    ds_read_b128 v[184:187], v221 offset:704
    v_mfma_f32_16x16x32_f16 v[52:55], v[84:87], v[96:99], v[52:55]
    v_mfma_f32_16x16x32_f16 v[56:59], v[84:87], v[100:103], v[56:59]
    ds_read_b128 v[156:159], v220 offset:3776
    v_mfma_f32_16x16x32_f16 v[60:63], v[84:87], v[104:107], v[60:63]
    v_mfma_f32_16x16x32_f16 v[56:59], v[64:67], v[120:123], v[56:59]
    v_mfma_f32_16x16x32_f16 v[60:63], v[68:71], v[120:123], v[60:63]
    v_mfma_f32_16x16x32_f16 v[56:59], v[88:91], v[96:99], v[56:59]
    v_mfma_f32_16x16x32_f16 v[60:63], v[88:91], v[100:103], v[60:63]
    v_mfma_f32_16x16x32_f16 v[60:63], v[64:67], v[124:127], v[60:63]
    v_mfma_f32_16x16x32_f16 v[60:63], v[92:95], v[96:99], v[60:63]
    s_waitcnt lgkmcnt(4)
    ds_read_b128 v[188:191], v221 offset:192
    s_waitcnt lgkmcnt(0)
    ds_read_b64 v[192:193], v222 offset:0
    ds_read_b64 v[194:195], v222 offset:512
    ds_read_b64 v[196:197], v222 offset:1024
    ds_read_b64 v[198:199], v222 offset:1536
    v_mfma_f32_16x16x32_f16 v[32:35], v[128:131], v[160:163], v[32:35]
    v_mfma_f32_16x16x32_f16 v[36:39], v[128:131], v[164:167], v[36:39]
    v_mfma_f32_16x16x32_f16 v[36:39], v[132:135], v[160:163], v[36:39]
    v_mfma_f32_16x16x32_f16 v[40:43], v[132:135], v[164:167], v[40:43]
    v_mfma_f32_16x16x32_f16 v[40:43], v[128:131], v[168:171], v[40:43]
    s_waitcnt lgkmcnt(0)
    s_lshl_b32 s30, s63, 16
    s_and_b32 s31, s63, 0xffff0000
    s_cmp_eq_u32 s21, 0
    s_cselect_b32 s30, s30, s31
    v_mfma_f32_16x16x32_f16 v[44:47], v[132:135], v[168:171], v[44:47]
    v_cvt_f32_f16 v64, v192
    v_lshrrev_b32 v65, 16, v192
    v_cvt_f32_f16 v65, v65
    v_mfma_f32_16x16x32_f16 v[40:43], v[136:139], v[160:163], v[40:43]
    v_cvt_f32_f16 v66, v193
    v_lshrrev_b32 v67, 16, v193
    v_cvt_f32_f16 v67, v67
    v_mfma_f32_16x16x32_f16 v[44:47], v[136:139], v[164:167], v[44:47]
    v_cvt_f32_f16 v68, v194
    v_lshrrev_b32 v69, 16, v194
    v_cvt_f32_f16 v69, v69
    v_mfma_f32_16x16x32_f16 v[48:51], v[136:139], v[168:171], v[48:51]
    v_cvt_f32_f16 v70, v195
    v_lshrrev_b32 v71, 16, v195
    v_cvt_f32_f16 v71, v71
    v_mfma_f32_16x16x32_f16 v[44:47], v[128:131], v[172:175], v[44:47]
    v_cvt_f32_f16 v72, v196
    v_lshrrev_b32 v73, 16, v196
    v_cvt_f32_f16 v73, v73
    v_mfma_f32_16x16x32_f16 v[48:51], v[132:135], v[172:175], v[48:51]
    v_cvt_f32_f16 v74, v197
    v_lshrrev_b32 v75, 16, v197
    v_cvt_f32_f16 v75, v75
    v_mfma_f32_16x16x32_f16 v[52:55], v[136:139], v[172:175], v[52:55]
    v_cvt_f32_f16 v76, v198
    v_lshrrev_b32 v77, 16, v198
    v_cvt_f32_f16 v77, v77
    v_mfma_f32_16x16x32_f16 v[44:47], v[140:143], v[160:163], v[44:47]
    v_cvt_f32_f16 v78, v199
    v_lshrrev_b32 v79, 16, v199
    v_cvt_f32_f16 v79, v79
    v_mfma_f32_16x16x32_f16 v[48:51], v[140:143], v[164:167], v[48:51]
    v_mul_f32 v64, s30, v64
    v_mul_f32 v65, s30, v65
    v_cvt_pk_bf16_f32 v192, v64, v65
    v_mfma_f32_16x16x32_f16 v[52:55], v[140:143], v[168:171], v[52:55]
    v_mul_f32 v66, s30, v66
    v_mul_f32 v67, s30, v67
    v_cvt_pk_bf16_f32 v193, v66, v67
    v_mfma_f32_16x16x32_f16 v[56:59], v[140:143], v[172:175], v[56:59]
    v_mul_f32 v68, s30, v68
    v_mul_f32 v69, s30, v69
    v_cvt_pk_bf16_f32 v194, v68, v69
    v_mfma_f32_16x16x32_f16 v[48:51], v[128:131], v[176:179], v[48:51]
    v_mul_f32 v70, s30, v70
    v_mul_f32 v71, s30, v71
    v_cvt_pk_bf16_f32 v195, v70, v71
    v_mfma_f32_16x16x32_f16 v[52:55], v[132:135], v[176:179], v[52:55]
    v_mul_f32 v72, s30, v72
    v_mul_f32 v73, s30, v73
    v_cvt_pk_bf16_f32 v196, v72, v73
    v_mfma_f32_16x16x32_f16 v[56:59], v[136:139], v[176:179], v[56:59]
    v_mul_f32 v74, s30, v74
    v_mul_f32 v75, s30, v75
    v_cvt_pk_bf16_f32 v197, v74, v75
    v_mfma_f32_16x16x32_f16 v[60:63], v[140:143], v[176:179], v[60:63]
    v_mul_f32 v76, s30, v76
    v_mul_f32 v77, s30, v77
    v_cvt_pk_bf16_f32 v198, v76, v77
    v_mfma_f32_16x16x32_f16 v[48:51], v[144:147], v[160:163], v[48:51]
    v_mul_f32 v78, s30, v78
    v_mul_f32 v79, s30, v79
    v_cvt_pk_bf16_f32 v199, v78, v79
    v_mfma_f32_16x16x32_f16 v[52:55], v[144:147], v[164:167], v[52:55]
    v_lshlrev_b32 v64, 16, v192
    v_and_b32 v65, s19, v192
    v_mfma_f32_16x16x32_f16 v[56:59], v[144:147], v[168:171], v[56:59]
    v_lshlrev_b32 v66, 16, v193
    v_and_b32 v67, s19, v193
    v_mfma_f32_16x16x32_f16 v[60:63], v[144:147], v[172:175], v[60:63]
    v_lshlrev_b32 v68, 16, v194
    v_and_b32 v69, s19, v194
    v_mfma_f32_16x16x32_f16 v[52:55], v[128:131], v[180:183], v[52:55]
    v_lshlrev_b32 v70, 16, v195
    v_and_b32 v71, s19, v195
    v_mfma_f32_16x16x32_f16 v[56:59], v[132:135], v[180:183], v[56:59]
    v_lshlrev_b32 v72, 16, v196
    v_and_b32 v73, s19, v196
    v_mfma_f32_16x16x32_f16 v[60:63], v[136:139], v[180:183], v[60:63]
    v_lshlrev_b32 v74, 16, v197
    v_and_b32 v75, s19, v197
    v_mfma_f32_16x16x32_f16 v[52:55], v[148:151], v[160:163], v[52:55]
    v_lshlrev_b32 v76, 16, v198
    v_and_b32 v77, s19, v198
    v_mfma_f32_16x16x32_f16 v[56:59], v[148:151], v[164:167], v[56:59]
    v_lshlrev_b32 v78, 16, v199
    v_and_b32 v79, s19, v199
    v_mfma_f32_16x16x32_f16 v[60:63], v[148:151], v[168:171], v[60:63]
    v_mfma_f32_16x16x32_f16 v[56:59], v[128:131], v[184:187], v[56:59]
    v_mfma_f32_16x16x32_f16 v[60:63], v[132:135], v[184:187], v[60:63]
    v_mfma_f32_16x16x32_f16 v[56:59], v[152:155], v[160:163], v[56:59]
    v_mfma_f32_16x16x32_f16 v[60:63], v[152:155], v[164:167], v[60:63]
    v_mfma_f32_16x16x32_f16 v[60:63], v[128:131], v[188:191], v[60:63]
    v_mfma_f32_16x16x32_f16 v[60:63], v[156:159], v[160:163], v[60:63]
    s_setprio 3
    s_lshl_b32 s17, s23, 12
    s_lshl_b32 s18, s22, 11
    s_add_u32 s17, s17, s18
    s_add_u32 s17, s17, 10485760
    s_cmp_eq_u32 s22, 0
    s_nop 0
    s_cbranch_scc0 S_e1
    ds_write_b128 v224, v[48:51] offset:0
    ds_write_b128 v224, v[52:55] offset:1024
    ds_write_b128 v224, v[56:59] offset:2048
    ds_write_b128 v224, v[60:63] offset:3072
    s_waitcnt lgkmcnt(0)
    s_barrier
    ds_read_b128 v[80:83], v225 offset:0
    ds_read_b128 v[84:87], v225 offset:1024
    ds_read_b128 v[88:91], v225 offset:2048
    ds_read_b128 v[92:95], v225 offset:3072
    s_waitcnt lgkmcnt(3)
    v_add_f32 v80, v80, v32
    v_add_f32 v81, v81, v33
    v_add_f32 v82, v82, v34
    v_add_f32 v83, v83, v35
    s_waitcnt lgkmcnt(2)
    v_add_f32 v84, v84, v36
    v_add_f32 v85, v85, v37
    v_add_f32 v86, v86, v38
    v_add_f32 v87, v87, v39
    s_waitcnt lgkmcnt(1)
    v_add_f32 v88, v88, v40
    v_add_f32 v89, v89, v41
    v_add_f32 v90, v90, v42
    v_add_f32 v91, v91, v43
    s_waitcnt lgkmcnt(0)
    v_add_f32 v92, v92, v44
    v_add_f32 v93, v93, v45
    v_add_f32 v94, v94, v46
    v_add_f32 v95, v95, v47
    s_nop 0
    s_branch S_e2
S_e1:
    ds_write_b128 v224, v[32:35] offset:0
    ds_write_b128 v224, v[36:39] offset:1024
    ds_write_b128 v224, v[40:43] offset:2048
    ds_write_b128 v224, v[44:47] offset:3072
    s_waitcnt lgkmcnt(0)
    s_barrier
    ds_read_b128 v[80:83], v225 offset:0
    ds_read_b128 v[84:87], v225 offset:1024
    ds_read_b128 v[88:91], v225 offset:2048
    ds_read_b128 v[92:95], v225 offset:3072
    s_waitcnt lgkmcnt(3)
    v_add_f32 v80, v80, v48
    v_add_f32 v81, v81, v49
    v_add_f32 v82, v82, v50
    v_add_f32 v83, v83, v51
    s_waitcnt lgkmcnt(2)
    v_add_f32 v84, v84, v52
    v_add_f32 v85, v85, v53
    v_add_f32 v86, v86, v54
    v_add_f32 v87, v87, v55
    s_waitcnt lgkmcnt(1)
    v_add_f32 v88, v88, v56
    v_add_f32 v89, v89, v57
    v_add_f32 v90, v90, v58
    v_add_f32 v91, v91, v59
    s_waitcnt lgkmcnt(0)
    v_add_f32 v92, v92, v60
    v_add_f32 v93, v93, v61
    v_add_f32 v94, v94, v62
    v_add_f32 v95, v95, v63
S_e2:
    v_mul_f32 v80, v80, v249
    v_mul_f32 v81, v81, v249
    v_mul_f32 v82, v82, v249
    v_mul_f32 v83, v83, v249
    v_mul_f32 v84, v84, v249
    v_mul_f32 v85, v85, v249
    v_mul_f32 v86, v86, v249
    v_mul_f32 v87, v87, v249
    v_mul_f32 v88, v88, v249
    v_mul_f32 v89, v89, v249
    v_mul_f32 v90, v90, v249
    v_mul_f32 v91, v91, v249
    v_mul_f32 v92, v92, v249
    v_mul_f32 v93, v93, v249
    v_mul_f32 v94, v94, v249
    v_mul_f32 v95, v95, v249
    v_cvt_pk_bf16_f32 v96, v80, v81
    v_cvt_pk_bf16_f32 v97, v82, v83
    v_cvt_pk_bf16_f32 v98, v84, v85
    v_cvt_pk_bf16_f32 v99, v86, v87
    v_cvt_pk_bf16_f32 v100, v88, v89
    v_cvt_pk_bf16_f32 v101, v90, v91
    v_cvt_pk_bf16_f32 v102, v92, v93
    v_cvt_pk_bf16_f32 v103, v94, v95
    v_lshlrev_b32 v80, 16, v96
    v_and_b32 v81, s19, v96
    v_lshlrev_b32 v82, 16, v97
    v_and_b32 v83, s19, v97
    v_lshlrev_b32 v84, 16, v98
    v_and_b32 v85, s19, v98
    v_lshlrev_b32 v86, 16, v99
    v_and_b32 v87, s19, v99
    v_lshlrev_b32 v88, 16, v100
    v_and_b32 v89, s19, v100
    v_lshlrev_b32 v90, 16, v101
    v_and_b32 v91, s19, v101
    v_lshlrev_b32 v92, 16, v102
    v_and_b32 v93, s19, v102
    v_lshlrev_b32 v94, 16, v103
    v_and_b32 v95, s19, v103
    v_add_f32 v80, v80, v64
    v_add_f32 v81, v81, v65
    v_add_f32 v82, v82, v66
    v_add_f32 v83, v83, v67
    v_add_f32 v84, v84, v68
    v_add_f32 v85, v85, v69
    v_add_f32 v86, v86, v70
    v_add_f32 v87, v87, v71
    v_add_f32 v88, v88, v72
    v_add_f32 v89, v89, v73
    v_add_f32 v90, v90, v74
    v_add_f32 v91, v91, v75
    v_add_f32 v92, v92, v76
    v_add_f32 v93, v93, v77
    v_add_f32 v94, v94, v78
    v_add_f32 v95, v95, v79
    v_cvt_pk_bf16_f32 v96, v80, v81
    v_cvt_pk_bf16_f32 v97, v82, v83
    v_cvt_pk_bf16_f32 v98, v84, v85
    v_cvt_pk_bf16_f32 v99, v86, v87
    v_cvt_pk_bf16_f32 v100, v88, v89
    v_cvt_pk_bf16_f32 v101, v90, v91
    v_cvt_pk_bf16_f32 v102, v92, v93
    v_cvt_pk_bf16_f32 v103, v94, v95
    buffer_store_dwordx2 v[96:97], v223, s[4:7], s17 offen offset:0 sc1
    buffer_store_dwordx2 v[98:99], v223, s[4:7], s17 offen offset:512 sc1
    buffer_store_dwordx2 v[100:101], v223, s[4:7], s17 offen offset:1024 sc1
    buffer_store_dwordx2 v[102:103], v223, s[4:7], s17 offen offset:1536 sc1
    s_lshl_b32 s17, s3, 2
    s_add_u32 s17, s17, 73728
    s_waitcnt vmcnt(0)
    s_barrier
    s_cmp_lg_u32 s20, 0
    s_cbranch_scc1 S_nofz
    s_mov_b64 exec, 1
    buffer_atomic_swap v226, v227, s[4:7], s17 offen sc1
    s_mov_b64 exec, -1
S_nofz:
    s_cmp_lg_u32 s20, 1
    s_cbranch_scc1 S_fin
    s_cmp_lg_u32 s3, 0
    s_cbranch_scc1 S_fin
    s_mov_b32 s17, 69632
    v_lshrrev_b32 v24, 2, v2
    v_lshlrev_b32 v24, 7, v24
    v_and_b32 v25, 3, v2
    v_lshl_add_u32 v24, v25, 4, v24
    s_mov_b32 s12, 0
S_fs_poll:
    buffer_load_dwordx4 v[20:23], v24, s[4:7], s17 offen sc1
    s_add_u32 s12, s12, 1
    s_waitcnt vmcnt(0)
    v_xor_b32 v255, v20, v226
    v_xor_b32 v254, v21, v226
    v_or_b32 v255, v255, v254
    v_xor_b32 v254, v22, v226
    v_or_b32 v255, v255, v254
    v_xor_b32 v254, v23, v226
    v_or_b32 v255, v255, v254
    v_cmp_ne_u32 vcc, 0, v255
    s_nop 3
    s_cbranch_vccz S_fs_ok
    s_cmp_gt_u32 s12, 200000
    s_cbranch_scc1 S_fs_ok
    s_sleep 16
    s_branch S_fs_poll
S_fs_ok:
    s_mov_b32 s17, 81920
    s_mov_b64 exec, 1
    buffer_store_dword v226, v227, s[4:7], s17 offen sc1
    s_mov_b64 exec, -1
S_fin:
    s_endpgm
K_done:
    s_endpgm
.section .rodata,"a"
.p2align 6
.amdhsa_kernel parallel_sum__ssm_conv_s4d__dense_activation_relu__prompt_kernel
  .amdhsa_next_free_vgpr 256
  .amdhsa_next_free_sgpr 102
  .amdhsa_accum_offset 256
  .amdhsa_group_segment_fixed_size 0
  .amdhsa_kernarg_size 104
  .amdhsa_user_sgpr_count 2
  .amdhsa_user_sgpr_kernarg_segment_ptr 1
  .amdhsa_system_sgpr_workgroup_id_x 1
  .amdhsa_ieee_mode 0
.end_amdhsa_kernel
```
